```python
import torch

def _softmax(x, axis=-1):
    return torch.softmax(x, dim=axis)
def _gelu(x):
    return torch.nn.functional.gelu(x, approximate="tanh")
def _silu(x):
    return torch.nn.functional.silu(x)
def _sigmoid(x):
    return torch.sigmoid(x)
def _layernorm(x, axis=-1, eps=1e-5):
    m = x.mean(dim=axis, keepdim=True)
    v = x.var(dim=axis, keepdim=True, unbiased=False)
    return (x - m) / torch.sqrt(v + eps)
def _scatter_add(tgt, idx, src, axis=0):
    return tgt.clone().index_add_(axis, idx, src)
def _segment_sum(src, seg, n):
    out = torch.zeros((n,) + src.shape[1:], dtype=src.dtype)
    return out.index_add_(0, seg, src)
def _pad(x, pw):
    flat = tuple(v for pair in reversed(pw) for v in pair)
    return torch.nn.functional.pad(x, flat)

kernel_name = 'gated_mix__grouped_kv_mqa__glu_gated_reglu__prompt'

def setup_inputs():

    _w = (lambda a: (lambda t: t.to(torch.bfloat16) if t.is_floating_point() else t)(torch.as_tensor(a)))
    def _A_setup():
        B, S, D, H = 1, 2048, 640, 32
        Dh = D // H
        return {
            "x": _w((lambda *s: torch.randn(*s, dtype=torch.bfloat16) * 0.05)(B, S, D)),
            "wq": _w((lambda *s: torch.randn(*s, dtype=torch.bfloat16) * 0.8)(D, H * Dh)),
            "wk": _w((lambda *s: torch.randn(*s, dtype=torch.bfloat16) * 0.8)(D, Dh)),
            "wv": _w((lambda *s: torch.randn(*s, dtype=torch.bfloat16) * 0.05)(D, Dh)),
            "wo": _w((lambda *s: torch.randn(*s, dtype=torch.bfloat16) * 0.05)(H * Dh, D)),
        }
    _A_in = _A_setup()

    def _B_setup():
        B, S, D, F = 1, 2048, 640, 1536
        return {
            "x": _w((lambda *s: torch.randn(*s, dtype=torch.bfloat16) * 0.05)(B, S, D)),
            "W_gate": _w((lambda *s: torch.randn(*s, dtype=torch.bfloat16) * 0.8)(D, F) * (2.0 / D) ** 0.5),
            "W_up": _w((lambda *s: torch.randn(*s, dtype=torch.bfloat16) * 0.8)(D, F) * (2.0 / D) ** 0.5),
            "W_down": _w((lambda *s: torch.randn(*s, dtype=torch.bfloat16) * 0.8)(F, D) * (1.0 / F) ** 0.5),
        }
    _B_in = _B_setup()

    return {
        "A_x": _A_in["x"],
        "A_wq": _A_in["wq"],
        "A_wk": _A_in["wk"],
        "A_wv": _A_in["wv"],
        "A_wo": _A_in["wo"],
        "B_x": _B_in["x"],
        "B_W_gate": _B_in["W_gate"],
        "B_W_up": _B_in["W_up"],
        "B_W_down": _B_in["W_down"],
        "gate_w": _w((lambda *s: torch.randn(*s, dtype=torch.bfloat16) * 0.05)(640) * 16.0),
    }

def reference(A_x, A_wq, A_wk, A_wv, A_wo, B_x, B_W_gate, B_W_up, B_W_down, gate_w):
    def _A_ref(x, wq, wk, wv, wo):
        B, S, D = x.shape
        H = 32
        Dh = D // H
        q = (lambda x, *d: x.permute(*d))((x @ wq).reshape(B, S, H, Dh), 0, 2, 1, 3)
        k = x @ wk
        v = x @ wv
        scores = torch.einsum("bhqd,bkd->bhqk", q, k) * (Dh ** -0.5)
        p = _softmax(scores, axis=-1)
        o = torch.einsum("bhqk,bkd->bhqd", p, v)
        return (lambda x, *d: x.permute(*d))(o, 0, 2, 1, 3).reshape(B, S, H * Dh) @ wo

    def _B_ref(x, W_gate, W_up, W_down):
        gate = torch.einsum("bsd,df->bsf", x, W_gate)
        up = torch.einsum("bsd,df->bsf", x, W_up)
        gate = gate * (lambda x, dt: x.to(dt))(gate > 0, gate.dtype)
        h = gate * up
        return torch.einsum("bsf,fd->bsd", h, W_down)

    x = A_x
    g = _sigmoid((x * gate_w).sum(-1, keepdims=True))
    a = _A_ref(x, A_wq, A_wk, A_wv, A_wo)
    b = _B_ref(x, B_W_gate, B_W_up, B_W_down)
    return g * a + (1 - g) * b
```

```asm
; @launch grid=(256,1,1) block=(768,1,1) lds=159808
.amdgcn_target "amdgcn-amd-amdhsa--gfx950"
.text
.globl gated_mix__grouped_kv_mqa__glu_gated_reglu__prompt_kernel
.p2align 8
.type gated_mix__grouped_kv_mqa__glu_gated_reglu__prompt_kernel,@function
gated_mix__grouped_kv_mqa__glu_gated_reglu__prompt_kernel:
    s_cmp_ge_u32 s2, 256
    s_cbranch_scc1 K2_END
    s_load_dwordx4 s[4:7], s[0:1], 0
    s_load_dwordx4 s[8:11], s[0:1], 16
    s_load_dwordx4 s[12:15], s[0:1], 48
    s_load_dwordx2 s[16:17], s[0:1], 72
    s_load_dwordx2 s[18:19], s[0:1], 96
    s_load_dwordx2 s[60:61], s[0:1], 32
    s_load_dwordx2 s[62:63], s[0:1], 64
    s_load_dwordx2 s[64:65], s[0:1], 88
    s_load_dwordx2 s[66:67], s[0:1], 80
    v_lshrrev_b32 v1, 6, v0
    v_and_b32 v0, 63, v0
    s_nop 0
    v_readfirstlane_b32 s20, v1
    s_nop 3
    s_mov_b32 s79, s20
    s_and_b32 s3, s2, 7
    s_lshr_b32 s21, s2, 3
    s_and_b32 s22, s3, 1
    s_lshl_b32 s22, s22, 3
    s_and_b32 s23, s21, 7
    s_add_u32 s22, s22, s23
    s_lshr_b32 s23, s3, 1
    s_lshl_b32 s23, s23, 2
    s_lshr_b32 s21, s21, 3
    s_add_u32 s23, s23, s21
    s_waitcnt lgkmcnt(0)
    s_mov_b32 s24, s4
    s_mov_b32 s25, s5
    s_mov_b32 s26, 2621440
    s_mov_b32 s27, 0x00020000
    s_mov_b32 s28, s18
    s_mov_b32 s29, s19
    s_mov_b32 s30, 18874368
    s_mov_b32 s31, 0x00020000
    s_cmp_eq_u32 s23, 15
    s_cbranch_scc1 K1_ROLE_C
    s_cmp_ge_u32 s23, 12
    s_cbranch_scc1 K1_SETUP_B
    s_lshl_b32 s21, s23, 8
    s_sub_u32 s3, 1966080, s21
    s_add_u32 s32, s12, s21
    s_addc_u32 s33, s13, 0
    s_mov_b32 s34, s3
    s_mov_b32 s35, 0x00020000
    s_add_u32 s36, s14, s21
    s_addc_u32 s37, s15, 0
    s_mov_b32 s38, s3
    s_mov_b32 s39, 0x00020000
    s_mov_b32 s40, 3072
    s_branch K1_GEMM
K1_SETUP_B:
    s_sub_u32 s21, s23, 12
    s_lshl_b32 s21, s21, 9
    s_sub_u32 s3, 819200, s21
    s_add_u32 s32, s6, s21
    s_addc_u32 s33, s7, 0
    s_mov_b32 s34, s3
    s_mov_b32 s35, 0x00020000
    s_add_u32 s21, s21, 256
    s_sub_u32 s3, 819200, s21
    s_add_u32 s36, s6, s21
    s_addc_u32 s37, s7, 0
    s_mov_b32 s38, s3
    s_mov_b32 s39, 0x00020000
    s_mov_b32 s40, 1280
K1_GEMM:
    s_mov_b32 s56, 1
    s_cmp_ge_u32 s20, 8
    s_cbranch_scc1 K1_HELP
    s_lshl_b32 s41, s40, 2
    s_lshl_b32 s44, s40, 6
    s_lshl_b32 s45, s40, 3
    s_mul_i32 s45, s45, s20
    s_mul_i32 s46, s22, 163840
    s_lshl_b32 s47, s20, 10
    s_lshl_b32 s48, s20, 11
    s_add_u32 s48, s48, 16384
    s_lshr_b32 s49, s20, 2
    s_and_b32 s50, s20, 3
    s_and_b32 s51, s20, 1
    v_lshrrev_b32 v3, 3, v0
    s_lshl_b32 s3, s20, 3
    v_add_u32 v3, s3, v3
    v_mul_u32_u24 v3, 0x500, v3
    v_lshrrev_b32 v4, 4, v0
    s_lshl_b32 s3, s51, 2
    v_add_u32 v4, s3, v4
    v_and_b32 v4, 7, v4
    v_and_b32 v5, 7, v0
    v_xor_b32 v4, v4, v5
    v_lshl_add_u32 v2, v4, 4, v3
    v_lshrrev_b32 v4, 4, v0
    v_mul_lo_u32 v3, v4, s40
    v_lshlrev_b32 v4, 2, v4
    v_and_b32 v5, 15, v0
    v_xor_b32 v4, v4, v5
    v_lshl_add_u32 v1, v4, 4, v3
    s_mov_b32 s52, 0
    v_lshrrev_b32 v3, 3, v0
    v_mul_u32_u24 v3, 0x500, v3
    v_and_b32 v4, 7, v0
    v_lshl_add_u32 v3, v4, 4, v3
    s_and_b32 s3, s23, 3
    s_lshl_b32 s3, s3, 5
    s_lshl_b32 s53, s50, 3
    s_add_u32 s3, s3, s53
    s_mul_i32 s3, s3, 1280
    s_add_u32 s3, s3, s46
    s_lshl_b32 s53, s49, 7
    s_add_u32 s3, s3, s53
    v_lshrrev_b32 v4, 4, v0
    v_mul_lo_u32 v4, v4, s40
    v_and_b32 v5, 15, v0
    v_lshl_add_u32 v4, v5, 4, v4
    s_and_b32 s53, s22, 7
    s_lshl_b32 s53, s53, 3
    s_lshl_b32 s55, s51, 2
    s_add_u32 s53, s53, s55
    s_lshl_b32 s55, s49, 6
    s_add_u32 s53, s53, s55
    s_mul_i32 s53, s53, s40
    s_lshl_b32 s55, s40, 7
    s_bitcmp1_b32 s20, 1
    s_cselect_b32 s72, s36, s32
    s_cselect_b32 s73, s37, s33
    s_cselect_b32 s74, s38, s34
    s_cselect_b32 s75, s39, s35
    s_add_u32 s57, s3, 256
    v_mov_b32 v25, v3
    v_mov_b32 v26, v4
    s_mov_b32 s58, s55
    buffer_load_dwordx4 v[160:163], v3, s[24:27], s3 offen offset:0
    buffer_load_dwordx4 v[164:167], v4, s[72:75], s53 offen
    s_add_u32 s53, s53, s55
    s_barrier
    v_and_b32 v3, 31, v0
    s_lshl_b32 s3, s49, 6
    v_add_u32 v3, s3, v3
    v_lshrrev_b32 v4, 1, v3
    v_and_b32 v4, 7, v4
    v_lshrrev_b32 v5, 5, v0
    v_lshlrev_b32 v3, 7, v3
    v_or_b32 v24, 0, v5
    v_xor_b32 v24, v24, v4
    v_lshl_add_u32 v6, v24, 4, v3
    v_mov_b32 v11, v6
    v_or_b32 v24, 2, v5
    v_xor_b32 v24, v24, v4
    v_lshl_add_u32 v7, v24, 4, v3
    v_mov_b32 v12, v7
    v_or_b32 v24, 4, v5
    v_xor_b32 v24, v24, v4
    v_lshl_add_u32 v8, v24, 4, v3
    v_mov_b32 v13, v8
    v_or_b32 v24, 6, v5
    v_xor_b32 v24, v24, v4
    v_lshl_add_u32 v9, v24, 4, v3
    v_mov_b32 v14, v9
    v_bfe_u32 v3, v0, 2, 2
    v_lshl_add_u32 v4, v5, 3, v3
    v_lshlrev_b32 v4, 8, v4
    v_bfe_u32 v24, v0, 4, 1
    v_lshl_add_u32 v4, v24, 5, v4
    v_and_b32 v24, 3, v0
    v_lshl_add_u32 v4, v24, 3, v4
    v_xor_b32 v24, s50, v3
    v_lshl_add_u32 v10, v24, 6, v4
    v_mov_b32 v15, v10
    v_add_u32 v16, 49152, v6
    v_add_u32 v17, 49152, v10
    s_mov_b32 s54, 49152
    v_mov_b32 v96, 0
    v_mov_b32 v97, 0
    v_mov_b32 v98, 0
    v_mov_b32 v99, 0
    v_mov_b32 v100, 0
    v_mov_b32 v101, 0
    v_mov_b32 v102, 0
    v_mov_b32 v103, 0
    v_mov_b32 v104, 0
    v_mov_b32 v105, 0
    v_mov_b32 v106, 0
    v_mov_b32 v107, 0
    v_mov_b32 v108, 0
    v_mov_b32 v109, 0
    v_mov_b32 v110, 0
    v_mov_b32 v111, 0
    v_mov_b32 v112, 0
    v_mov_b32 v113, 0
    v_mov_b32 v114, 0
    v_mov_b32 v115, 0
    v_mov_b32 v116, 0
    v_mov_b32 v117, 0
    v_mov_b32 v118, 0
    v_mov_b32 v119, 0
    v_mov_b32 v120, 0
    v_mov_b32 v121, 0
    v_mov_b32 v122, 0
    v_mov_b32 v123, 0
    v_mov_b32 v124, 0
    v_mov_b32 v125, 0
    v_mov_b32 v126, 0
    v_mov_b32 v127, 0
    v_mov_b32 v128, 0
    v_mov_b32 v129, 0
    v_mov_b32 v130, 0
    v_mov_b32 v131, 0
    v_mov_b32 v132, 0
    v_mov_b32 v133, 0
    v_mov_b32 v134, 0
    v_mov_b32 v135, 0
    v_mov_b32 v136, 0
    v_mov_b32 v137, 0
    v_mov_b32 v138, 0
    v_mov_b32 v139, 0
    v_mov_b32 v140, 0
    v_mov_b32 v141, 0
    v_mov_b32 v142, 0
    v_mov_b32 v143, 0
    v_mov_b32 v144, 0
    v_mov_b32 v145, 0
    v_mov_b32 v146, 0
    v_mov_b32 v147, 0
    v_mov_b32 v148, 0
    v_mov_b32 v149, 0
    v_mov_b32 v150, 0
    v_mov_b32 v151, 0
    v_mov_b32 v152, 0
    v_mov_b32 v153, 0
    v_mov_b32 v154, 0
    v_mov_b32 v155, 0
    v_mov_b32 v156, 0
    v_mov_b32 v157, 0
    v_mov_b32 v158, 0
    v_mov_b32 v159, 0
    s_barrier
    ds_read_b128 v[32:35], v11 offset:0
    ds_read_b128 v[36:39], v11 offset:4096
    ds_read_b64_tr_b16 v[40:41], v15 offset:16384
    ds_read_b64_tr_b16 v[42:43], v15 offset:17408
    ds_read_b64_tr_b16 v[44:45], v15 offset:32768
    ds_read_b64_tr_b16 v[46:47], v15 offset:33792
    s_mov_b32 s55, 0
.p2align 6
K1_L1:
    s_waitcnt lgkmcnt(0)
    v_mfma_f32_32x32x16_bf16 v[96:111], v[40:43], v[32:35], v[96:111]
    ds_read_b128 v[48:51], v12 offset:0
    ds_read_b128 v[52:55], v12 offset:4096
    v_mfma_f32_32x32x16_bf16 v[128:143], v[44:47], v[32:35], v[128:143]
    ds_read_b64_tr_b16 v[56:57], v15 offset:20480
    v_mfma_f32_32x32x16_bf16 v[112:127], v[40:43], v[36:39], v[112:127]
    ds_read_b64_tr_b16 v[58:59], v15 offset:21504
    ds_read_b64_tr_b16 v[60:61], v15 offset:36864
    v_mfma_f32_32x32x16_bf16 v[144:159], v[44:47], v[36:39], v[144:159]
    ds_read_b64_tr_b16 v[62:63], v15 offset:37888
    s_cmp_lt_u32 s55, 4
    s_cbranch_scc0 K1_NPF
    buffer_load_dwordx4 v[160:163], v25, s[24:27], s57 offen
    buffer_load_dwordx4 v[164:167], v26, s[72:75], s53 offen
    s_add_u32 s53, s53, s58
    s_add_u32 s57, s57, 256
K1_NPF:
    s_waitcnt lgkmcnt(0)
    v_mfma_f32_32x32x16_bf16 v[96:111], v[56:59], v[48:51], v[96:111]
    ds_read_b128 v[32:35], v13 offset:0
    ds_read_b128 v[36:39], v13 offset:4096
    v_mfma_f32_32x32x16_bf16 v[128:143], v[60:63], v[48:51], v[128:143]
    ds_read_b64_tr_b16 v[40:41], v15 offset:24576
    v_mfma_f32_32x32x16_bf16 v[112:127], v[56:59], v[52:55], v[112:127]
    ds_read_b64_tr_b16 v[42:43], v15 offset:25600
    ds_read_b64_tr_b16 v[44:45], v15 offset:40960
    v_mfma_f32_32x32x16_bf16 v[144:159], v[60:63], v[52:55], v[144:159]
    ds_read_b64_tr_b16 v[46:47], v15 offset:41984
    s_waitcnt lgkmcnt(0)
    v_mfma_f32_32x32x16_bf16 v[96:111], v[40:43], v[32:35], v[96:111]
    ds_read_b128 v[48:51], v14 offset:0
    ds_read_b128 v[52:55], v14 offset:4096
    v_mfma_f32_32x32x16_bf16 v[128:143], v[44:47], v[32:35], v[128:143]
    ds_read_b64_tr_b16 v[56:57], v15 offset:28672
    v_mfma_f32_32x32x16_bf16 v[112:127], v[40:43], v[36:39], v[112:127]
    ds_read_b64_tr_b16 v[58:59], v15 offset:29696
    ds_read_b64_tr_b16 v[60:61], v15 offset:45056
    v_mfma_f32_32x32x16_bf16 v[144:159], v[44:47], v[36:39], v[144:159]
    ds_read_b64_tr_b16 v[62:63], v15 offset:46080
    s_waitcnt lgkmcnt(0)
    s_barrier
    v_mfma_f32_32x32x16_bf16 v[96:111], v[56:59], v[48:51], v[96:111]
    ds_read_b128 v[32:35], v16 offset:0
    ds_read_b128 v[36:39], v16 offset:4096
    v_mfma_f32_32x32x16_bf16 v[128:143], v[60:63], v[48:51], v[128:143]
    ds_read_b64_tr_b16 v[40:41], v17 offset:16384
    v_mfma_f32_32x32x16_bf16 v[112:127], v[56:59], v[52:55], v[112:127]
    ds_read_b64_tr_b16 v[42:43], v17 offset:17408
    ds_read_b64_tr_b16 v[44:45], v17 offset:32768
    v_mfma_f32_32x32x16_bf16 v[144:159], v[60:63], v[52:55], v[144:159]
    ds_read_b64_tr_b16 v[46:47], v17 offset:33792
    v_add_u32 v11, s54, v6
    v_add_u32 v12, s54, v7
    v_add_u32 v13, s54, v8
    v_add_u32 v14, s54, v9
    v_mov_b32 v15, v17
    s_add_u32 s54, s54, 49152
    s_cmp_ge_u32 s54, 147456
    s_cselect_b32 s3, 147456, 0
    s_sub_u32 s54, s54, s3
    v_add_u32 v16, s54, v6
    v_add_u32 v17, s54, v10
    s_add_u32 s55, s55, 1
    s_cmp_lt_u32 s55, 7
    s_cbranch_scc1 K1_L1
K1_L2:
    s_waitcnt lgkmcnt(0)
    v_mfma_f32_32x32x16_bf16 v[96:111], v[40:43], v[32:35], v[96:111]
    ds_read_b128 v[48:51], v12 offset:0
    ds_read_b128 v[52:55], v12 offset:4096
    v_mfma_f32_32x32x16_bf16 v[128:143], v[44:47], v[32:35], v[128:143]
    ds_read_b64_tr_b16 v[56:57], v15 offset:20480
    v_mfma_f32_32x32x16_bf16 v[112:127], v[40:43], v[36:39], v[112:127]
    ds_read_b64_tr_b16 v[58:59], v15 offset:21504
    ds_read_b64_tr_b16 v[60:61], v15 offset:36864
    v_mfma_f32_32x32x16_bf16 v[144:159], v[44:47], v[36:39], v[144:159]
    ds_read_b64_tr_b16 v[62:63], v15 offset:37888
    s_waitcnt lgkmcnt(0)
    v_mfma_f32_32x32x16_bf16 v[96:111], v[56:59], v[48:51], v[96:111]
    ds_read_b128 v[32:35], v13 offset:0
    ds_read_b128 v[36:39], v13 offset:4096
    v_mfma_f32_32x32x16_bf16 v[128:143], v[60:63], v[48:51], v[128:143]
    ds_read_b64_tr_b16 v[40:41], v15 offset:24576
    v_mfma_f32_32x32x16_bf16 v[112:127], v[56:59], v[52:55], v[112:127]
    ds_read_b64_tr_b16 v[42:43], v15 offset:25600
    ds_read_b64_tr_b16 v[44:45], v15 offset:40960
    v_mfma_f32_32x32x16_bf16 v[144:159], v[60:63], v[52:55], v[144:159]
    ds_read_b64_tr_b16 v[46:47], v15 offset:41984
    s_waitcnt lgkmcnt(0)
    v_mfma_f32_32x32x16_bf16 v[96:111], v[40:43], v[32:35], v[96:111]
    ds_read_b128 v[48:51], v14 offset:0
    ds_read_b128 v[52:55], v14 offset:4096
    v_mfma_f32_32x32x16_bf16 v[128:143], v[44:47], v[32:35], v[128:143]
    ds_read_b64_tr_b16 v[56:57], v15 offset:28672
    v_mfma_f32_32x32x16_bf16 v[112:127], v[40:43], v[36:39], v[112:127]
    ds_read_b64_tr_b16 v[58:59], v15 offset:29696
    ds_read_b64_tr_b16 v[60:61], v15 offset:45056
    v_mfma_f32_32x32x16_bf16 v[144:159], v[44:47], v[36:39], v[144:159]
    ds_read_b64_tr_b16 v[62:63], v15 offset:46080
    s_waitcnt lgkmcnt(0)
    s_barrier
    v_mfma_f32_32x32x16_bf16 v[96:111], v[56:59], v[48:51], v[96:111]
    ds_read_b128 v[32:35], v16 offset:0
    ds_read_b128 v[36:39], v16 offset:4096
    v_mfma_f32_32x32x16_bf16 v[128:143], v[60:63], v[48:51], v[128:143]
    ds_read_b64_tr_b16 v[40:41], v17 offset:16384
    v_mfma_f32_32x32x16_bf16 v[112:127], v[56:59], v[52:55], v[112:127]
    ds_read_b64_tr_b16 v[42:43], v17 offset:17408
    ds_read_b64_tr_b16 v[44:45], v17 offset:32768
    v_mfma_f32_32x32x16_bf16 v[144:159], v[60:63], v[52:55], v[144:159]
    ds_read_b64_tr_b16 v[46:47], v17 offset:33792
    v_add_u32 v11, s54, v6
    v_add_u32 v12, s54, v7
    v_add_u32 v13, s54, v8
    v_add_u32 v14, s54, v9
    v_mov_b32 v15, v17
    s_add_u32 s54, s54, 49152
    s_cmp_ge_u32 s54, 147456
    s_cselect_b32 s3, 147456, 0
    s_sub_u32 s54, s54, s3
    v_add_u32 v16, s54, v6
    v_add_u32 v17, s54, v10
    s_add_u32 s55, s55, 1
    s_cmp_lt_u32 s55, 10
    s_cbranch_scc1 K1_L2
    s_nop 15
    s_cmp_ge_u32 s23, 12
    s_cbranch_scc1 K1_EPI_B
    s_lshl_b32 s3, s22, 2
    s_lshl_b32 s21, s49, 1
    s_add_u32 s3, s3, s21
    s_mul_i32 s3, s3, 96
    s_lshl_b32 s21, s23, 3
    s_add_u32 s3, s3, s21
    s_lshl_b32 s21, s50, 1
    s_add_u32 s3, s3, s21
    s_lshl_b32 s3, s3, 10
    s_add_u32 s3, s3, 3145728
    s_add_u32 s21, s3, 98304
    v_lshlrev_b32 v1, 4, v0
    v_max_f32 v96, 0, v96
    v_mul_f32 v96, v96, v128
    v_max_f32 v97, 0, v97
    v_mul_f32 v97, v97, v129
    v_max_f32 v98, 0, v98
    v_mul_f32 v98, v98, v130
    v_max_f32 v99, 0, v99
    v_mul_f32 v99, v99, v131
    v_max_f32 v100, 0, v100
    v_mul_f32 v100, v100, v132
    v_max_f32 v101, 0, v101
    v_mul_f32 v101, v101, v133
    v_max_f32 v102, 0, v102
    v_mul_f32 v102, v102, v134
    v_max_f32 v103, 0, v103
    v_mul_f32 v103, v103, v135
    v_max_f32 v104, 0, v104
    v_mul_f32 v104, v104, v136
    v_max_f32 v105, 0, v105
    v_mul_f32 v105, v105, v137
    v_max_f32 v106, 0, v106
    v_mul_f32 v106, v106, v138
    v_max_f32 v107, 0, v107
    v_mul_f32 v107, v107, v139
    v_max_f32 v108, 0, v108
    v_mul_f32 v108, v108, v140
    v_max_f32 v109, 0, v109
    v_mul_f32 v109, v109, v141
    v_max_f32 v110, 0, v110
    v_mul_f32 v110, v110, v142
    v_max_f32 v111, 0, v111
    v_mul_f32 v111, v111, v143
    v_cvt_pk_bf16_f32 v64, v96, v97
    v_cvt_pk_bf16_f32 v65, v98, v99
    v_cvt_pk_bf16_f32 v66, v100, v101
    v_cvt_pk_bf16_f32 v67, v102, v103
    v_cvt_pk_bf16_f32 v68, v104, v105
    v_cvt_pk_bf16_f32 v69, v106, v107
    v_cvt_pk_bf16_f32 v70, v108, v109
    v_cvt_pk_bf16_f32 v71, v110, v111
    buffer_store_dwordx4 v[64:67], v1, s[28:31], s3 offen offset:0 sc1
    buffer_store_dwordx4 v[68:71], v1, s[28:31], s3 offen offset:1024 sc1
    v_max_f32 v112, 0, v112
    v_mul_f32 v112, v112, v144
    v_max_f32 v113, 0, v113
    v_mul_f32 v113, v113, v145
    v_max_f32 v114, 0, v114
    v_mul_f32 v114, v114, v146
    v_max_f32 v115, 0, v115
    v_mul_f32 v115, v115, v147
    v_max_f32 v116, 0, v116
    v_mul_f32 v116, v116, v148
    v_max_f32 v117, 0, v117
    v_mul_f32 v117, v117, v149
    v_max_f32 v118, 0, v118
    v_mul_f32 v118, v118, v150
    v_max_f32 v119, 0, v119
    v_mul_f32 v119, v119, v151
    v_max_f32 v120, 0, v120
    v_mul_f32 v120, v120, v152
    v_max_f32 v121, 0, v121
    v_mul_f32 v121, v121, v153
    v_max_f32 v122, 0, v122
    v_mul_f32 v122, v122, v154
    v_max_f32 v123, 0, v123
    v_mul_f32 v123, v123, v155
    v_max_f32 v124, 0, v124
    v_mul_f32 v124, v124, v156
    v_max_f32 v125, 0, v125
    v_mul_f32 v125, v125, v157
    v_max_f32 v126, 0, v126
    v_mul_f32 v126, v126, v158
    v_max_f32 v127, 0, v127
    v_mul_f32 v127, v127, v159
    v_cvt_pk_bf16_f32 v72, v112, v113
    v_cvt_pk_bf16_f32 v73, v114, v115
    v_cvt_pk_bf16_f32 v74, v116, v117
    v_cvt_pk_bf16_f32 v75, v118, v119
    v_cvt_pk_bf16_f32 v76, v120, v121
    v_cvt_pk_bf16_f32 v77, v122, v123
    v_cvt_pk_bf16_f32 v78, v124, v125
    v_cvt_pk_bf16_f32 v79, v126, v127
    buffer_store_dwordx4 v[72:75], v1, s[28:31], s21 offen offset:0 sc1
    buffer_store_dwordx4 v[76:79], v1, s[28:31], s21 offen offset:1024 sc1
    s_mov_b64 exec, -1
    s_branch P1_DONE
K1_EPI_B:
    s_sub_u32 s3, s23, 12
    s_lshl_b32 s3, s3, 6
    s_lshl_b32 s21, s50, 3
    s_add_u32 s3, s3, s21
    s_lshl_b32 s3, s3, 14
    s_lshl_b32 s21, s22, 7
    s_lshl_b32 s51, s49, 6
    s_add_u32 s21, s21, s51
    s_lshl_b32 s21, s21, 3
    s_add_u32 s3, s3, s21
    v_and_b32 v1, 31, v0
    v_lshlrev_b32 v1, 3, v1
    v_lshrrev_b32 v2, 5, v0
    v_lshl_add_u32 v1, v2, 14, v1
    s_mov_b32 s51, 0x3ea52b5c
    v_mul_f32 v96, s51, v96
    v_mul_f32 v97, s51, v97
    v_mul_f32 v98, s51, v98
    v_mul_f32 v99, s51, v99
    v_mul_f32 v100, s51, v100
    v_mul_f32 v101, s51, v101
    v_mul_f32 v102, s51, v102
    v_mul_f32 v103, s51, v103
    v_mul_f32 v104, s51, v104
    v_mul_f32 v105, s51, v105
    v_mul_f32 v106, s51, v106
    v_mul_f32 v107, s51, v107
    v_mul_f32 v108, s51, v108
    v_mul_f32 v109, s51, v109
    v_mul_f32 v110, s51, v110
    v_mul_f32 v111, s51, v111
    v_cvt_pk_bf16_f32 v64, v96, v97
    v_cvt_pk_bf16_f32 v65, v98, v99
    v_cvt_pk_bf16_f32 v66, v100, v101
    v_cvt_pk_bf16_f32 v67, v102, v103
    v_cvt_pk_bf16_f32 v68, v104, v105
    v_cvt_pk_bf16_f32 v69, v106, v107
    v_cvt_pk_bf16_f32 v70, v108, v109
    v_cvt_pk_bf16_f32 v71, v110, v111
    s_add_u32 s21, s3, 0
    buffer_store_dwordx2 v[64:65], v1, s[28:31], s21 offen offset:0 sc1
    s_add_u32 s21, s3, 32768
    buffer_store_dwordx2 v[66:67], v1, s[28:31], s21 offen offset:0 sc1
    s_add_u32 s21, s3, 65536
    buffer_store_dwordx2 v[68:69], v1, s[28:31], s21 offen offset:0 sc1
    s_add_u32 s21, s3, 98304
    buffer_store_dwordx2 v[70:71], v1, s[28:31], s21 offen offset:0 sc1
    v_mul_f32 v112, s51, v112
    v_mul_f32 v113, s51, v113
    v_mul_f32 v114, s51, v114
    v_mul_f32 v115, s51, v115
    v_mul_f32 v116, s51, v116
    v_mul_f32 v117, s51, v117
    v_mul_f32 v118, s51, v118
    v_mul_f32 v119, s51, v119
    v_mul_f32 v120, s51, v120
    v_mul_f32 v121, s51, v121
    v_mul_f32 v122, s51, v122
    v_mul_f32 v123, s51, v123
    v_mul_f32 v124, s51, v124
    v_mul_f32 v125, s51, v125
    v_mul_f32 v126, s51, v126
    v_mul_f32 v127, s51, v127
    v_cvt_pk_bf16_f32 v72, v112, v113
    v_cvt_pk_bf16_f32 v73, v114, v115
    v_cvt_pk_bf16_f32 v74, v116, v117
    v_cvt_pk_bf16_f32 v75, v118, v119
    v_cvt_pk_bf16_f32 v76, v120, v121
    v_cvt_pk_bf16_f32 v77, v122, v123
    v_cvt_pk_bf16_f32 v78, v124, v125
    v_cvt_pk_bf16_f32 v79, v126, v127
    s_add_u32 s21, s3, 0
    buffer_store_dwordx2 v[72:73], v1, s[28:31], s21 offen offset:256 sc1
    s_add_u32 s21, s3, 32768
    buffer_store_dwordx2 v[74:75], v1, s[28:31], s21 offen offset:256 sc1
    s_add_u32 s21, s3, 65536
    buffer_store_dwordx2 v[76:77], v1, s[28:31], s21 offen offset:256 sc1
    s_add_u32 s21, s3, 98304
    buffer_store_dwordx2 v[78:79], v1, s[28:31], s21 offen offset:256 sc1
    s_cmp_eq_u32 s23, 14
    s_cbranch_scc1 P1_DONE
    v_mul_f32 v128, s51, v128
    v_mul_f32 v129, s51, v129
    v_mul_f32 v130, s51, v130
    v_mul_f32 v131, s51, v131
    v_mul_f32 v132, s51, v132
    v_mul_f32 v133, s51, v133
    v_mul_f32 v134, s51, v134
    v_mul_f32 v135, s51, v135
    v_mul_f32 v136, s51, v136
    v_mul_f32 v137, s51, v137
    v_mul_f32 v138, s51, v138
    v_mul_f32 v139, s51, v139
    v_mul_f32 v140, s51, v140
    v_mul_f32 v141, s51, v141
    v_mul_f32 v142, s51, v142
    v_mul_f32 v143, s51, v143
    v_cvt_pk_bf16_f32 v80, v128, v129
    v_cvt_pk_bf16_f32 v81, v130, v131
    v_cvt_pk_bf16_f32 v82, v132, v133
    v_cvt_pk_bf16_f32 v83, v134, v135
    v_cvt_pk_bf16_f32 v84, v136, v137
    v_cvt_pk_bf16_f32 v85, v138, v139
    v_cvt_pk_bf16_f32 v86, v140, v141
    v_cvt_pk_bf16_f32 v87, v142, v143
    s_add_u32 s21, s3, 524288
    buffer_store_dwordx2 v[80:81], v1, s[28:31], s21 offen offset:0 sc1
    s_add_u32 s21, s3, 557056
    buffer_store_dwordx2 v[82:83], v1, s[28:31], s21 offen offset:0 sc1
    s_add_u32 s21, s3, 589824
    buffer_store_dwordx2 v[84:85], v1, s[28:31], s21 offen offset:0 sc1
    s_add_u32 s21, s3, 622592
    buffer_store_dwordx2 v[86:87], v1, s[28:31], s21 offen offset:0 sc1
    v_mul_f32 v144, s51, v144
    v_mul_f32 v145, s51, v145
    v_mul_f32 v146, s51, v146
    v_mul_f32 v147, s51, v147
    v_mul_f32 v148, s51, v148
    v_mul_f32 v149, s51, v149
    v_mul_f32 v150, s51, v150
    v_mul_f32 v151, s51, v151
    v_mul_f32 v152, s51, v152
    v_mul_f32 v153, s51, v153
    v_mul_f32 v154, s51, v154
    v_mul_f32 v155, s51, v155
    v_mul_f32 v156, s51, v156
    v_mul_f32 v157, s51, v157
    v_mul_f32 v158, s51, v158
    v_mul_f32 v159, s51, v159
    v_cvt_pk_bf16_f32 v88, v144, v145
    v_cvt_pk_bf16_f32 v89, v146, v147
    v_cvt_pk_bf16_f32 v90, v148, v149
    v_cvt_pk_bf16_f32 v91, v150, v151
    v_cvt_pk_bf16_f32 v92, v152, v153
    v_cvt_pk_bf16_f32 v93, v154, v155
    v_cvt_pk_bf16_f32 v94, v156, v157
    v_cvt_pk_bf16_f32 v95, v158, v159
    s_add_u32 s21, s3, 524288
    buffer_store_dwordx2 v[88:89], v1, s[28:31], s21 offen offset:256 sc1
    s_add_u32 s21, s3, 557056
    buffer_store_dwordx2 v[90:91], v1, s[28:31], s21 offen offset:256 sc1
    s_add_u32 s21, s3, 589824
    buffer_store_dwordx2 v[92:93], v1, s[28:31], s21 offen offset:256 sc1
    s_add_u32 s21, s3, 622592
    buffer_store_dwordx2 v[94:95], v1, s[28:31], s21 offen offset:256 sc1
    s_branch P1_DONE
K1_ROLE_C:
    s_mov_b32 s56, 0
    s_cmp_ge_u32 s20, 8
    s_cbranch_scc1 K1_HELP
    s_mov_b32 s32, s8
    s_mov_b32 s33, s9
    s_mov_b32 s34, 25600
    s_mov_b32 s35, 0x00020000
    s_mov_b32 s36, s10
    s_mov_b32 s37, s11
    s_mov_b32 s38, 25600
    s_mov_b32 s39, 0x00020000
    s_mov_b32 s40, s16
    s_mov_b32 s41, s17
    s_mov_b32 s42, 1280
    s_mov_b32 s43, 0x00020000
    s_and_b32 s3, s20, 3
    s_lshl_b32 s21, s22, 2
    s_add_u32 s21, s21, s3
    s_lshl_b32 s44, s20, 6
    v_add_u32 v3, s44, v0
    v_lshlrev_b32 v4, 2, v3
    buffer_load_dword v8, v4, s[32:35], 0 offen offset:0
    buffer_load_dword v33, v4, s[36:39], 0 offen offset:0
    buffer_load_dword v9, v4, s[32:35], 0 offen offset:2048
    buffer_load_dword v34, v4, s[36:39], 0 offen offset:2048
    v_add_u32 v4, 4096, v4
    buffer_load_dword v10, v4, s[32:35], 0 offen offset:0
    buffer_load_dword v35, v4, s[36:39], 0 offen offset:0
    buffer_load_dword v11, v4, s[32:35], 0 offen offset:2048
    buffer_load_dword v36, v4, s[36:39], 0 offen offset:2048
    v_add_u32 v4, 4096, v4
    buffer_load_dword v12, v4, s[32:35], 0 offen offset:0
    buffer_load_dword v37, v4, s[36:39], 0 offen offset:0
    buffer_load_dword v13, v4, s[32:35], 0 offen offset:2048
    buffer_load_dword v38, v4, s[36:39], 0 offen offset:2048
    v_add_u32 v4, 4096, v4
    buffer_load_dword v14, v4, s[32:35], 0 offen offset:0
    buffer_load_dword v39, v4, s[36:39], 0 offen offset:0
    buffer_load_dword v15, v4, s[32:35], 0 offen offset:2048
    buffer_load_dword v40, v4, s[36:39], 0 offen offset:2048
    v_add_u32 v4, 4096, v4
    buffer_load_dword v16, v4, s[32:35], 0 offen offset:0
    buffer_load_dword v41, v4, s[36:39], 0 offen offset:0
    buffer_load_dword v17, v4, s[32:35], 0 offen offset:2048
    buffer_load_dword v42, v4, s[36:39], 0 offen offset:2048
    v_add_u32 v4, 4096, v4
    buffer_load_dword v18, v4, s[32:35], 0 offen offset:0
    buffer_load_dword v43, v4, s[36:39], 0 offen offset:0
    buffer_load_dword v19, v4, s[32:35], 0 offen offset:2048
    buffer_load_dword v44, v4, s[36:39], 0 offen offset:2048
    v_add_u32 v4, 4096, v4
    buffer_load_dword v20, v4, s[32:35], 0 offen offset:0
    buffer_load_dword v45, v4, s[36:39], 0 offen offset:0
    v_lshlrev_b32 v4, 1, v3
    buffer_load_ushort v58, v4, s[40:43], 0 offen offset:0
    buffer_load_ushort v59, v4, s[40:43], 0 offen offset:1024
    s_and_b32 s51, s20, 1
    v_lshrrev_b32 v5, 3, v0
    s_lshl_b32 s3, s20, 3
    v_add_u32 v5, s3, v5
    v_mul_u32_u24 v5, 0x500, v5
    v_lshrrev_b32 v6, 4, v0
    s_lshl_b32 s3, s51, 2
    v_add_u32 v6, s3, v6
    v_and_b32 v6, 7, v6
    v_and_b32 v7, 7, v0
    v_xor_b32 v6, v6, v7
    v_lshl_add_u32 v62, v6, 4, v5
    s_mul_i32 s46, s22, 163840
    s_lshl_b32 s47, s20, 10
    s_add_u32 m0, s47, 81920
    s_add_u32 s3, s46, 0
    buffer_load_dwordx4 v62, s[24:27], s3 offen lds
    s_add_u32 m0, s47, 90112
    s_add_u32 s3, s46, 81920
    buffer_load_dwordx4 v62, s[24:27], s3 offen lds
    s_add_u32 m0, s47, 98304
    s_add_u32 s3, s46, 128
    buffer_load_dwordx4 v62, s[24:27], s3 offen lds
    s_add_u32 m0, s47, 106496
    s_add_u32 s3, s46, 82048
    buffer_load_dwordx4 v62, s[24:27], s3 offen lds
    s_add_u32 m0, s47, 114688
    s_add_u32 s3, s46, 256
    buffer_load_dwordx4 v62, s[24:27], s3 offen lds
    s_add_u32 m0, s47, 122880
    s_add_u32 s3, s46, 82176
    buffer_load_dwordx4 v62, s[24:27], s3 offen lds
    v_mov_b32 v144, 0
    v_mov_b32 v145, 0
    v_mov_b32 v146, 0
    v_mov_b32 v147, 0
    v_lshlrev_b32 v4, 4, v3
    ds_write_b128 v4, v[144:147] offset:0
    ds_write_b128 v4, v[144:147] offset:8192
    ds_write_b128 v4, v[144:147] offset:16384
    ds_write_b128 v4, v[144:147] offset:24576
    ds_write_b128 v4, v[144:147] offset:32768
    ds_write_b128 v4, v[144:147] offset:40960
    ds_write_b128 v4, v[144:147] offset:49152
    ds_write_b128 v4, v[144:147] offset:57344
    v_add_u32 v5, 65536, v4
    ds_write_b128 v5, v[144:147] offset:0
    ds_write_b128 v5, v[144:147] offset:8192
    s_waitcnt lgkmcnt(0)
    s_barrier
    s_mov_b32 s3, 0xCCCCCCCD
    s_waitcnt vmcnt(6)
    v_add_u32 v4, 0, v3
    v_mul_hi_u32 v5, v4, s3
    v_lshrrev_b32 v5, 3, v5
    v_mul_u32_u24 v6, 10, v5
    v_sub_u32 v6, v4, v6
    v_lshlrev_b32 v5, 6, v5
    v_lshl_add_u32 v5, v6, 2, v5
    ds_write_b32 v5, v8
    ds_write_b32 v5, v33 offset:40960
    v_add_u32 v4, 512, v3
    v_mul_hi_u32 v5, v4, s3
    v_lshrrev_b32 v5, 3, v5
    v_mul_u32_u24 v6, 10, v5
    v_sub_u32 v6, v4, v6
    v_lshlrev_b32 v5, 6, v5
    v_lshl_add_u32 v5, v6, 2, v5
    ds_write_b32 v5, v9
    ds_write_b32 v5, v34 offset:40960
    v_add_u32 v4, 1024, v3
    v_mul_hi_u32 v5, v4, s3
    v_lshrrev_b32 v5, 3, v5
    v_mul_u32_u24 v6, 10, v5
    v_sub_u32 v6, v4, v6
    v_lshlrev_b32 v5, 6, v5
    v_lshl_add_u32 v5, v6, 2, v5
    ds_write_b32 v5, v10
    ds_write_b32 v5, v35 offset:40960
    v_add_u32 v4, 1536, v3
    v_mul_hi_u32 v5, v4, s3
    v_lshrrev_b32 v5, 3, v5
    v_mul_u32_u24 v6, 10, v5
    v_sub_u32 v6, v4, v6
    v_lshlrev_b32 v5, 6, v5
    v_lshl_add_u32 v5, v6, 2, v5
    ds_write_b32 v5, v11
    ds_write_b32 v5, v36 offset:40960
    v_add_u32 v4, 2048, v3
    v_mul_hi_u32 v5, v4, s3
    v_lshrrev_b32 v5, 3, v5
    v_mul_u32_u24 v6, 10, v5
    v_sub_u32 v6, v4, v6
    v_lshlrev_b32 v5, 6, v5
    v_lshl_add_u32 v5, v6, 2, v5
    ds_write_b32 v5, v12
    ds_write_b32 v5, v37 offset:40960
    v_add_u32 v4, 2560, v3
    v_mul_hi_u32 v5, v4, s3
    v_lshrrev_b32 v5, 3, v5
    v_mul_u32_u24 v6, 10, v5
    v_sub_u32 v6, v4, v6
    v_lshlrev_b32 v5, 6, v5
    v_lshl_add_u32 v5, v6, 2, v5
    ds_write_b32 v5, v13
    ds_write_b32 v5, v38 offset:40960
    v_add_u32 v4, 3072, v3
    v_mul_hi_u32 v5, v4, s3
    v_lshrrev_b32 v5, 3, v5
    v_mul_u32_u24 v6, 10, v5
    v_sub_u32 v6, v4, v6
    v_lshlrev_b32 v5, 6, v5
    v_lshl_add_u32 v5, v6, 2, v5
    ds_write_b32 v5, v14
    ds_write_b32 v5, v39 offset:40960
    v_add_u32 v4, 3584, v3
    v_mul_hi_u32 v5, v4, s3
    v_lshrrev_b32 v5, 3, v5
    v_mul_u32_u24 v6, 10, v5
    v_sub_u32 v6, v4, v6
    v_lshlrev_b32 v5, 6, v5
    v_lshl_add_u32 v5, v6, 2, v5
    ds_write_b32 v5, v15
    ds_write_b32 v5, v40 offset:40960
    v_add_u32 v4, 4096, v3
    v_mul_hi_u32 v5, v4, s3
    v_lshrrev_b32 v5, 3, v5
    v_mul_u32_u24 v6, 10, v5
    v_sub_u32 v6, v4, v6
    v_lshlrev_b32 v5, 6, v5
    v_lshl_add_u32 v5, v6, 2, v5
    ds_write_b32 v5, v16
    ds_write_b32 v5, v41 offset:40960
    v_add_u32 v4, 4608, v3
    v_mul_hi_u32 v5, v4, s3
    v_lshrrev_b32 v5, 3, v5
    v_mul_u32_u24 v6, 10, v5
    v_sub_u32 v6, v4, v6
    v_lshlrev_b32 v5, 6, v5
    v_lshl_add_u32 v5, v6, 2, v5
    ds_write_b32 v5, v17
    ds_write_b32 v5, v42 offset:40960
    v_add_u32 v4, 5120, v3
    v_mul_hi_u32 v5, v4, s3
    v_lshrrev_b32 v5, 3, v5
    v_mul_u32_u24 v6, 10, v5
    v_sub_u32 v6, v4, v6
    v_lshlrev_b32 v5, 6, v5
    v_lshl_add_u32 v5, v6, 2, v5
    ds_write_b32 v5, v18
    ds_write_b32 v5, v43 offset:40960
    v_add_u32 v4, 5632, v3
    v_mul_hi_u32 v5, v4, s3
    v_lshrrev_b32 v5, 3, v5
    v_mul_u32_u24 v6, 10, v5
    v_sub_u32 v6, v4, v6
    v_lshlrev_b32 v5, 6, v5
    v_lshl_add_u32 v5, v6, 2, v5
    ds_write_b32 v5, v19
    ds_write_b32 v5, v44 offset:40960
    v_add_u32 v4, 6144, v3
    v_mul_hi_u32 v5, v4, s3
    v_lshrrev_b32 v5, 3, v5
    v_mul_u32_u24 v6, 10, v5
    v_sub_u32 v6, v4, v6
    v_lshlrev_b32 v5, 6, v5
    v_lshl_add_u32 v5, v6, 2, v5
    v_cmp_gt_u32 vcc, 256, v3
    s_and_saveexec_b64 s[44:45], vcc
    ds_write_b32 v5, v20
    ds_write_b32 v5, v45 offset:40960
    s_mov_b64 exec, s[44:45]
    v_lshlrev_b32 v4, 6, v3
    ds_write_b16 v4, v58 offset:44
    v_cmp_gt_u32 vcc, 128, v3
    s_and_saveexec_b64 s[44:45], vcc
    ds_write_b16 v4, v59 offset:32812
    s_mov_b64 exec, s[44:45]
    s_waitcnt lgkmcnt(0)
    s_barrier
    v_bfe_u32 v3, v0, 2, 2
    v_lshrrev_b32 v5, 5, v0
    v_lshl_add_u32 v4, v5, 3, v3
    v_lshlrev_b32 v4, 6, v4
    v_bfe_u32 v6, v0, 4, 1
    v_lshl_add_u32 v4, v6, 5, v4
    v_and_b32 v6, 3, v0
    v_lshl_add_u32 v4, v6, 3, v4
    s_mul_i32 s48, s21, 3584
    s_add_u32 s48, s48, 2621440
    v_lshlrev_b32 v1, 4, v0
    v_lshlrev_b32 v2, 3, v0
    v_mov_b32 v60, 0x3f803f80
    v_mov_b32 v61, 0
    v_and_b32 v5, 31, v0
    s_and_b32 s44, s20, 3
    s_lshl_b32 s44, s44, 5
    v_add_u32 v5, s44, v5
    v_lshrrev_b32 v6, 1, v5
    v_and_b32 v6, 7, v6
    v_lshrrev_b32 v7, 5, v0
    v_lshlrev_b32 v5, 7, v5
    v_add_u32 v5, 81920, v5
    v_or_b32 v24, 0, v7
    v_xor_b32 v24, v24, v6
    v_lshl_add_u32 v64, v24, 4, v5
    v_or_b32 v24, 2, v7
    v_xor_b32 v24, v24, v6
    v_lshl_add_u32 v65, v24, 4, v5
    v_or_b32 v24, 4, v7
    v_xor_b32 v24, v24, v6
    v_lshl_add_u32 v66, v24, 4, v5
    v_or_b32 v24, 6, v7
    v_xor_b32 v24, v24, v6
    v_lshl_add_u32 v67, v24, 4, v5
    s_cmp_ge_u32 s20, 4
    s_cbranch_scc1 K1_C_V
    s_waitcnt vmcnt(4)
    s_barrier
    s_add_u32 m0, s47, 131072
    s_add_u32 s3, s46, 384
    buffer_load_dwordx4 v62, s[24:27], s3 offen lds
    s_add_u32 m0, s47, 139264
    s_add_u32 s3, s46, 82304
    buffer_load_dwordx4 v62, s[24:27], s3 offen lds
    ds_read_b128 v[72:75], v64 offset:0
    ds_read_b64_tr_b16 v[8:9], v4 offset:0
    ds_read_b64_tr_b16 v[10:11], v4 offset:256
    ds_read_b128 v[76:79], v65 offset:0
    ds_read_b64_tr_b16 v[12:13], v4 offset:1024
    ds_read_b64_tr_b16 v[14:15], v4 offset:1280
    ds_read_b128 v[80:83], v66 offset:0
    ds_read_b64_tr_b16 v[16:17], v4 offset:2048
    ds_read_b64_tr_b16 v[18:19], v4 offset:2304
    ds_read_b128 v[84:87], v67 offset:0
    ds_read_b64_tr_b16 v[20:21], v4 offset:3072
    ds_read_b64_tr_b16 v[22:23], v4 offset:3328
    s_waitcnt lgkmcnt(9)
    v_mfma_f32_32x32x16_bf16 v[144:159], v[8:11], v[72:75], 0
    s_waitcnt lgkmcnt(6)
    v_mfma_f32_32x32x16_bf16 v[144:159], v[12:15], v[76:79], v[144:159]
    s_waitcnt lgkmcnt(3)
    v_mfma_f32_32x32x16_bf16 v[144:159], v[16:19], v[80:83], v[144:159]
    s_waitcnt lgkmcnt(0)
    v_mfma_f32_32x32x16_bf16 v[144:159], v[20:23], v[84:87], v[144:159]
    s_waitcnt vmcnt(4)
    s_barrier
    s_add_u32 m0, s47, 81920
    s_add_u32 s3, s46, 512
    buffer_load_dwordx4 v62, s[24:27], s3 offen lds
    s_add_u32 m0, s47, 90112
    s_add_u32 s3, s46, 82432
    buffer_load_dwordx4 v62, s[24:27], s3 offen lds
    ds_read_b128 v[72:75], v64 offset:16384
    ds_read_b64_tr_b16 v[8:9], v4 offset:4096
    ds_read_b64_tr_b16 v[10:11], v4 offset:4352
    ds_read_b128 v[76:79], v65 offset:16384
    ds_read_b64_tr_b16 v[12:13], v4 offset:5120
    ds_read_b64_tr_b16 v[14:15], v4 offset:5376
    ds_read_b128 v[80:83], v66 offset:16384
    ds_read_b64_tr_b16 v[16:17], v4 offset:6144
    ds_read_b64_tr_b16 v[18:19], v4 offset:6400
    ds_read_b128 v[84:87], v67 offset:16384
    ds_read_b64_tr_b16 v[20:21], v4 offset:7168
    ds_read_b64_tr_b16 v[22:23], v4 offset:7424
    s_waitcnt lgkmcnt(9)
    v_mfma_f32_32x32x16_bf16 v[144:159], v[8:11], v[72:75], v[144:159]
    s_waitcnt lgkmcnt(6)
    v_mfma_f32_32x32x16_bf16 v[144:159], v[12:15], v[76:79], v[144:159]
    s_waitcnt lgkmcnt(3)
    v_mfma_f32_32x32x16_bf16 v[144:159], v[16:19], v[80:83], v[144:159]
    s_waitcnt lgkmcnt(0)
    v_mfma_f32_32x32x16_bf16 v[144:159], v[20:23], v[84:87], v[144:159]
    s_waitcnt vmcnt(4)
    s_barrier
    s_add_u32 m0, s47, 98304
    s_add_u32 s3, s46, 640
    buffer_load_dwordx4 v62, s[24:27], s3 offen lds
    s_add_u32 m0, s47, 106496
    s_add_u32 s3, s46, 82560
    buffer_load_dwordx4 v62, s[24:27], s3 offen lds
    ds_read_b128 v[72:75], v64 offset:32768
    ds_read_b64_tr_b16 v[8:9], v4 offset:8192
    ds_read_b64_tr_b16 v[10:11], v4 offset:8448
    ds_read_b128 v[76:79], v65 offset:32768
    ds_read_b64_tr_b16 v[12:13], v4 offset:9216
    ds_read_b64_tr_b16 v[14:15], v4 offset:9472
    ds_read_b128 v[80:83], v66 offset:32768
    ds_read_b64_tr_b16 v[16:17], v4 offset:10240
    ds_read_b64_tr_b16 v[18:19], v4 offset:10496
    ds_read_b128 v[84:87], v67 offset:32768
    ds_read_b64_tr_b16 v[20:21], v4 offset:11264
    ds_read_b64_tr_b16 v[22:23], v4 offset:11520
    s_waitcnt lgkmcnt(9)
    v_mfma_f32_32x32x16_bf16 v[144:159], v[8:11], v[72:75], v[144:159]
    s_waitcnt lgkmcnt(6)
    v_mfma_f32_32x32x16_bf16 v[144:159], v[12:15], v[76:79], v[144:159]
    s_waitcnt lgkmcnt(3)
    v_mfma_f32_32x32x16_bf16 v[144:159], v[16:19], v[80:83], v[144:159]
    s_waitcnt lgkmcnt(0)
    v_mfma_f32_32x32x16_bf16 v[144:159], v[20:23], v[84:87], v[144:159]
    s_waitcnt vmcnt(4)
    s_barrier
    s_add_u32 m0, s47, 114688
    s_add_u32 s3, s46, 768
    buffer_load_dwordx4 v62, s[24:27], s3 offen lds
    s_add_u32 m0, s47, 122880
    s_add_u32 s3, s46, 82688
    buffer_load_dwordx4 v62, s[24:27], s3 offen lds
    ds_read_b128 v[72:75], v64 offset:49152
    ds_read_b64_tr_b16 v[8:9], v4 offset:12288
    ds_read_b64_tr_b16 v[10:11], v4 offset:12544
    ds_read_b128 v[76:79], v65 offset:49152
    ds_read_b64_tr_b16 v[12:13], v4 offset:13312
    ds_read_b64_tr_b16 v[14:15], v4 offset:13568
    ds_read_b128 v[80:83], v66 offset:49152
    ds_read_b64_tr_b16 v[16:17], v4 offset:14336
    ds_read_b64_tr_b16 v[18:19], v4 offset:14592
    ds_read_b128 v[84:87], v67 offset:49152
    ds_read_b64_tr_b16 v[20:21], v4 offset:15360
    ds_read_b64_tr_b16 v[22:23], v4 offset:15616
    s_waitcnt lgkmcnt(9)
    v_mfma_f32_32x32x16_bf16 v[144:159], v[8:11], v[72:75], v[144:159]
    s_waitcnt lgkmcnt(6)
    v_mfma_f32_32x32x16_bf16 v[144:159], v[12:15], v[76:79], v[144:159]
    s_waitcnt lgkmcnt(3)
    v_mfma_f32_32x32x16_bf16 v[144:159], v[16:19], v[80:83], v[144:159]
    s_waitcnt lgkmcnt(0)
    v_mfma_f32_32x32x16_bf16 v[144:159], v[20:23], v[84:87], v[144:159]
    s_waitcnt vmcnt(4)
    s_barrier
    s_add_u32 m0, s47, 131072
    s_add_u32 s3, s46, 896
    buffer_load_dwordx4 v62, s[24:27], s3 offen lds
    s_add_u32 m0, s47, 139264
    s_add_u32 s3, s46, 82816
    buffer_load_dwordx4 v62, s[24:27], s3 offen lds
    ds_read_b128 v[72:75], v64 offset:0
    ds_read_b64_tr_b16 v[8:9], v4 offset:16384
    ds_read_b64_tr_b16 v[10:11], v4 offset:16640
    ds_read_b128 v[76:79], v65 offset:0
    ds_read_b64_tr_b16 v[12:13], v4 offset:17408
    ds_read_b64_tr_b16 v[14:15], v4 offset:17664
    ds_read_b128 v[80:83], v66 offset:0
    ds_read_b64_tr_b16 v[16:17], v4 offset:18432
    ds_read_b64_tr_b16 v[18:19], v4 offset:18688
    ds_read_b128 v[84:87], v67 offset:0
    ds_read_b64_tr_b16 v[20:21], v4 offset:19456
    ds_read_b64_tr_b16 v[22:23], v4 offset:19712
    s_waitcnt lgkmcnt(9)
    v_mfma_f32_32x32x16_bf16 v[144:159], v[8:11], v[72:75], v[144:159]
    s_waitcnt lgkmcnt(6)
    v_mfma_f32_32x32x16_bf16 v[144:159], v[12:15], v[76:79], v[144:159]
    s_waitcnt lgkmcnt(3)
    v_mfma_f32_32x32x16_bf16 v[144:159], v[16:19], v[80:83], v[144:159]
    s_waitcnt lgkmcnt(0)
    v_mfma_f32_32x32x16_bf16 v[144:159], v[20:23], v[84:87], v[144:159]
    s_waitcnt vmcnt(4)
    s_barrier
    s_add_u32 m0, s47, 81920
    s_add_u32 s3, s46, 1024
    buffer_load_dwordx4 v62, s[24:27], s3 offen lds
    s_add_u32 m0, s47, 90112
    s_add_u32 s3, s46, 82944
    buffer_load_dwordx4 v62, s[24:27], s3 offen lds
    ds_read_b128 v[72:75], v64 offset:16384
    ds_read_b64_tr_b16 v[8:9], v4 offset:20480
    ds_read_b64_tr_b16 v[10:11], v4 offset:20736
    ds_read_b128 v[76:79], v65 offset:16384
    ds_read_b64_tr_b16 v[12:13], v4 offset:21504
    ds_read_b64_tr_b16 v[14:15], v4 offset:21760
    ds_read_b128 v[80:83], v66 offset:16384
    ds_read_b64_tr_b16 v[16:17], v4 offset:22528
    ds_read_b64_tr_b16 v[18:19], v4 offset:22784
    ds_read_b128 v[84:87], v67 offset:16384
    ds_read_b64_tr_b16 v[20:21], v4 offset:23552
    ds_read_b64_tr_b16 v[22:23], v4 offset:23808
    s_waitcnt lgkmcnt(9)
    v_mfma_f32_32x32x16_bf16 v[144:159], v[8:11], v[72:75], v[144:159]
    s_waitcnt lgkmcnt(6)
    v_mfma_f32_32x32x16_bf16 v[144:159], v[12:15], v[76:79], v[144:159]
    s_waitcnt lgkmcnt(3)
    v_mfma_f32_32x32x16_bf16 v[144:159], v[16:19], v[80:83], v[144:159]
    s_waitcnt lgkmcnt(0)
    v_mfma_f32_32x32x16_bf16 v[144:159], v[20:23], v[84:87], v[144:159]
    s_waitcnt vmcnt(4)
    s_barrier
    s_add_u32 m0, s47, 98304
    s_add_u32 s3, s46, 1152
    buffer_load_dwordx4 v62, s[24:27], s3 offen lds
    s_add_u32 m0, s47, 106496
    s_add_u32 s3, s46, 83072
    buffer_load_dwordx4 v62, s[24:27], s3 offen lds
    ds_read_b128 v[72:75], v64 offset:32768
    ds_read_b64_tr_b16 v[8:9], v4 offset:24576
    ds_read_b64_tr_b16 v[10:11], v4 offset:24832
    ds_read_b128 v[76:79], v65 offset:32768
    ds_read_b64_tr_b16 v[12:13], v4 offset:25600
    ds_read_b64_tr_b16 v[14:15], v4 offset:25856
    ds_read_b128 v[80:83], v66 offset:32768
    ds_read_b64_tr_b16 v[16:17], v4 offset:26624
    ds_read_b64_tr_b16 v[18:19], v4 offset:26880
    ds_read_b128 v[84:87], v67 offset:32768
    ds_read_b64_tr_b16 v[20:21], v4 offset:27648
    ds_read_b64_tr_b16 v[22:23], v4 offset:27904
    s_waitcnt lgkmcnt(9)
    v_mfma_f32_32x32x16_bf16 v[144:159], v[8:11], v[72:75], v[144:159]
    s_waitcnt lgkmcnt(6)
    v_mfma_f32_32x32x16_bf16 v[144:159], v[12:15], v[76:79], v[144:159]
    s_waitcnt lgkmcnt(3)
    v_mfma_f32_32x32x16_bf16 v[144:159], v[16:19], v[80:83], v[144:159]
    s_waitcnt lgkmcnt(0)
    v_mfma_f32_32x32x16_bf16 v[144:159], v[20:23], v[84:87], v[144:159]
    s_waitcnt vmcnt(4)
    s_barrier
    ds_read_b128 v[72:75], v64 offset:49152
    ds_read_b64_tr_b16 v[8:9], v4 offset:28672
    ds_read_b64_tr_b16 v[10:11], v4 offset:28928
    ds_read_b128 v[76:79], v65 offset:49152
    ds_read_b64_tr_b16 v[12:13], v4 offset:29696
    ds_read_b64_tr_b16 v[14:15], v4 offset:29952
    ds_read_b128 v[80:83], v66 offset:49152
    ds_read_b64_tr_b16 v[16:17], v4 offset:30720
    ds_read_b64_tr_b16 v[18:19], v4 offset:30976
    ds_read_b128 v[84:87], v67 offset:49152
    ds_read_b64_tr_b16 v[20:21], v4 offset:31744
    ds_read_b64_tr_b16 v[22:23], v4 offset:32000
    s_waitcnt lgkmcnt(9)
    v_mfma_f32_32x32x16_bf16 v[144:159], v[8:11], v[72:75], v[144:159]
    s_waitcnt lgkmcnt(6)
    v_mfma_f32_32x32x16_bf16 v[144:159], v[12:15], v[76:79], v[144:159]
    s_waitcnt lgkmcnt(3)
    v_mfma_f32_32x32x16_bf16 v[144:159], v[16:19], v[80:83], v[144:159]
    s_waitcnt lgkmcnt(0)
    v_mfma_f32_32x32x16_bf16 v[144:159], v[20:23], v[84:87], v[144:159]
    s_waitcnt vmcnt(2)
    s_barrier
    ds_read_b128 v[72:75], v64 offset:0
    ds_read_b64_tr_b16 v[8:9], v4 offset:32768
    ds_read_b64_tr_b16 v[10:11], v4 offset:33024
    ds_read_b128 v[76:79], v65 offset:0
    ds_read_b64_tr_b16 v[12:13], v4 offset:33792
    ds_read_b64_tr_b16 v[14:15], v4 offset:34048
    ds_read_b128 v[80:83], v66 offset:0
    ds_read_b64_tr_b16 v[16:17], v4 offset:34816
    ds_read_b64_tr_b16 v[18:19], v4 offset:35072
    ds_read_b128 v[84:87], v67 offset:0
    ds_read_b64_tr_b16 v[20:21], v4 offset:35840
    ds_read_b64_tr_b16 v[22:23], v4 offset:36096
    s_waitcnt lgkmcnt(9)
    v_mfma_f32_32x32x16_bf16 v[144:159], v[8:11], v[72:75], v[144:159]
    s_waitcnt lgkmcnt(6)
    v_mfma_f32_32x32x16_bf16 v[144:159], v[12:15], v[76:79], v[144:159]
    s_waitcnt lgkmcnt(3)
    v_mfma_f32_32x32x16_bf16 v[144:159], v[16:19], v[80:83], v[144:159]
    s_waitcnt lgkmcnt(0)
    v_mfma_f32_32x32x16_bf16 v[144:159], v[20:23], v[84:87], v[144:159]
    s_waitcnt vmcnt(0)
    s_barrier
    ds_read_b128 v[72:75], v64 offset:16384
    ds_read_b64_tr_b16 v[8:9], v4 offset:36864
    ds_read_b64_tr_b16 v[10:11], v4 offset:37120
    ds_read_b128 v[76:79], v65 offset:16384
    ds_read_b64_tr_b16 v[12:13], v4 offset:37888
    ds_read_b64_tr_b16 v[14:15], v4 offset:38144
    ds_read_b128 v[80:83], v66 offset:16384
    ds_read_b64_tr_b16 v[16:17], v4 offset:38912
    ds_read_b64_tr_b16 v[18:19], v4 offset:39168
    ds_read_b128 v[84:87], v67 offset:16384
    ds_read_b64_tr_b16 v[20:21], v4 offset:39936
    ds_read_b64_tr_b16 v[22:23], v4 offset:40192
    s_waitcnt lgkmcnt(9)
    v_mfma_f32_32x32x16_bf16 v[144:159], v[8:11], v[72:75], v[144:159]
    s_waitcnt lgkmcnt(6)
    v_mfma_f32_32x32x16_bf16 v[144:159], v[12:15], v[76:79], v[144:159]
    s_waitcnt lgkmcnt(3)
    v_mfma_f32_32x32x16_bf16 v[144:159], v[16:19], v[80:83], v[144:159]
    s_waitcnt lgkmcnt(0)
    v_mfma_f32_32x32x16_bf16 v[144:159], v[20:23], v[84:87], v[144:159]
    s_nop 15
    v_cvt_pk_bf16_f32 v8, v144, v145
    v_cvt_pk_bf16_f32 v9, v146, v147
    v_cvt_pk_bf16_f32 v10, v148, v149
    v_cvt_pk_bf16_f32 v11, v150, v151
    v_cvt_pk_bf16_f32 v12, v152, v153
    v_cvt_pk_bf16_f32 v13, v154, v155
    v_mul_f32 v20, 0xbfb8aa3b, v154
    v_exp_f32 v20, v20
    s_nop 0
    v_add_f32 v20, 1.0, v20
    v_rcp_f32 v20, v20
    v_cmp_le_u32 vcc, 32, v0
    s_nop 1
    v_cndmask_b32 v12, v12, v60, vcc
    v_cndmask_b32 v13, v13, v61, vcc
    buffer_store_dwordx4 v[8:11], v1, s[28:31], s48 offen sc1
    buffer_store_dwordx2 v[12:13], v2, s[28:31], s48 offen offset:1024 sc1
    s_lshl_b32 s44, s21, 7
    s_add_u32 s44, s44, 2883456
    v_lshlrev_b32 v23, 2, v0
    s_and_saveexec_b64 s[46:47], vcc
    buffer_store_dword v20, v23, s[28:31], s44 offen sc1
    s_mov_b64 exec, -1
    s_branch P1_DONE
K1_C_V:
    v_add_u32 v4, 40960, v4
    s_waitcnt vmcnt(4)
    s_barrier
    s_add_u32 m0, s47, 131072
    s_add_u32 s3, s46, 384
    buffer_load_dwordx4 v62, s[24:27], s3 offen lds
    s_add_u32 m0, s47, 139264
    s_add_u32 s3, s46, 82304
    buffer_load_dwordx4 v62, s[24:27], s3 offen lds
    ds_read_b128 v[72:75], v64 offset:0
    ds_read_b64_tr_b16 v[8:9], v4 offset:0
    ds_read_b64_tr_b16 v[10:11], v4 offset:256
    ds_read_b128 v[76:79], v65 offset:0
    ds_read_b64_tr_b16 v[12:13], v4 offset:1024
    ds_read_b64_tr_b16 v[14:15], v4 offset:1280
    ds_read_b128 v[80:83], v66 offset:0
    ds_read_b64_tr_b16 v[16:17], v4 offset:2048
    ds_read_b64_tr_b16 v[18:19], v4 offset:2304
    ds_read_b128 v[84:87], v67 offset:0
    ds_read_b64_tr_b16 v[20:21], v4 offset:3072
    ds_read_b64_tr_b16 v[22:23], v4 offset:3328
    s_waitcnt lgkmcnt(9)
    v_mfma_f32_32x32x16_bf16 v[144:159], v[72:75], v[8:11], 0
    s_waitcnt lgkmcnt(6)
    v_mfma_f32_32x32x16_bf16 v[144:159], v[76:79], v[12:15], v[144:159]
    s_waitcnt lgkmcnt(3)
    v_mfma_f32_32x32x16_bf16 v[144:159], v[80:83], v[16:19], v[144:159]
    s_waitcnt lgkmcnt(0)
    v_mfma_f32_32x32x16_bf16 v[144:159], v[84:87], v[20:23], v[144:159]
    s_waitcnt vmcnt(4)
    s_barrier
    s_add_u32 m0, s47, 81920
    s_add_u32 s3, s46, 512
    buffer_load_dwordx4 v62, s[24:27], s3 offen lds
    s_add_u32 m0, s47, 90112
    s_add_u32 s3, s46, 82432
    buffer_load_dwordx4 v62, s[24:27], s3 offen lds
    ds_read_b128 v[72:75], v64 offset:16384
    ds_read_b64_tr_b16 v[8:9], v4 offset:4096
    ds_read_b64_tr_b16 v[10:11], v4 offset:4352
    ds_read_b128 v[76:79], v65 offset:16384
    ds_read_b64_tr_b16 v[12:13], v4 offset:5120
    ds_read_b64_tr_b16 v[14:15], v4 offset:5376
    ds_read_b128 v[80:83], v66 offset:16384
    ds_read_b64_tr_b16 v[16:17], v4 offset:6144
    ds_read_b64_tr_b16 v[18:19], v4 offset:6400
    ds_read_b128 v[84:87], v67 offset:16384
    ds_read_b64_tr_b16 v[20:21], v4 offset:7168
    ds_read_b64_tr_b16 v[22:23], v4 offset:7424
    s_waitcnt lgkmcnt(9)
    v_mfma_f32_32x32x16_bf16 v[144:159], v[72:75], v[8:11], v[144:159]
    s_waitcnt lgkmcnt(6)
    v_mfma_f32_32x32x16_bf16 v[144:159], v[76:79], v[12:15], v[144:159]
    s_waitcnt lgkmcnt(3)
    v_mfma_f32_32x32x16_bf16 v[144:159], v[80:83], v[16:19], v[144:159]
    s_waitcnt lgkmcnt(0)
    v_mfma_f32_32x32x16_bf16 v[144:159], v[84:87], v[20:23], v[144:159]
    s_waitcnt vmcnt(4)
    s_barrier
    s_add_u32 m0, s47, 98304
    s_add_u32 s3, s46, 640
    buffer_load_dwordx4 v62, s[24:27], s3 offen lds
    s_add_u32 m0, s47, 106496
    s_add_u32 s3, s46, 82560
    buffer_load_dwordx4 v62, s[24:27], s3 offen lds
    ds_read_b128 v[72:75], v64 offset:32768
    ds_read_b64_tr_b16 v[8:9], v4 offset:8192
    ds_read_b64_tr_b16 v[10:11], v4 offset:8448
    ds_read_b128 v[76:79], v65 offset:32768
    ds_read_b64_tr_b16 v[12:13], v4 offset:9216
    ds_read_b64_tr_b16 v[14:15], v4 offset:9472
    ds_read_b128 v[80:83], v66 offset:32768
    ds_read_b64_tr_b16 v[16:17], v4 offset:10240
    ds_read_b64_tr_b16 v[18:19], v4 offset:10496
    ds_read_b128 v[84:87], v67 offset:32768
    ds_read_b64_tr_b16 v[20:21], v4 offset:11264
    ds_read_b64_tr_b16 v[22:23], v4 offset:11520
    s_waitcnt lgkmcnt(9)
    v_mfma_f32_32x32x16_bf16 v[144:159], v[72:75], v[8:11], v[144:159]
    s_waitcnt lgkmcnt(6)
    v_mfma_f32_32x32x16_bf16 v[144:159], v[76:79], v[12:15], v[144:159]
    s_waitcnt lgkmcnt(3)
    v_mfma_f32_32x32x16_bf16 v[144:159], v[80:83], v[16:19], v[144:159]
    s_waitcnt lgkmcnt(0)
    v_mfma_f32_32x32x16_bf16 v[144:159], v[84:87], v[20:23], v[144:159]
    s_waitcnt vmcnt(4)
    s_barrier
    s_add_u32 m0, s47, 114688
    s_add_u32 s3, s46, 768
    buffer_load_dwordx4 v62, s[24:27], s3 offen lds
    s_add_u32 m0, s47, 122880
    s_add_u32 s3, s46, 82688
    buffer_load_dwordx4 v62, s[24:27], s3 offen lds
    ds_read_b128 v[72:75], v64 offset:49152
    ds_read_b64_tr_b16 v[8:9], v4 offset:12288
    ds_read_b64_tr_b16 v[10:11], v4 offset:12544
    ds_read_b128 v[76:79], v65 offset:49152
    ds_read_b64_tr_b16 v[12:13], v4 offset:13312
    ds_read_b64_tr_b16 v[14:15], v4 offset:13568
    ds_read_b128 v[80:83], v66 offset:49152
    ds_read_b64_tr_b16 v[16:17], v4 offset:14336
    ds_read_b64_tr_b16 v[18:19], v4 offset:14592
    ds_read_b128 v[84:87], v67 offset:49152
    ds_read_b64_tr_b16 v[20:21], v4 offset:15360
    ds_read_b64_tr_b16 v[22:23], v4 offset:15616
    s_waitcnt lgkmcnt(9)
    v_mfma_f32_32x32x16_bf16 v[144:159], v[72:75], v[8:11], v[144:159]
    s_waitcnt lgkmcnt(6)
    v_mfma_f32_32x32x16_bf16 v[144:159], v[76:79], v[12:15], v[144:159]
    s_waitcnt lgkmcnt(3)
    v_mfma_f32_32x32x16_bf16 v[144:159], v[80:83], v[16:19], v[144:159]
    s_waitcnt lgkmcnt(0)
    v_mfma_f32_32x32x16_bf16 v[144:159], v[84:87], v[20:23], v[144:159]
    s_waitcnt vmcnt(4)
    s_barrier
    s_add_u32 m0, s47, 131072
    s_add_u32 s3, s46, 896
    buffer_load_dwordx4 v62, s[24:27], s3 offen lds
    s_add_u32 m0, s47, 139264
    s_add_u32 s3, s46, 82816
    buffer_load_dwordx4 v62, s[24:27], s3 offen lds
    ds_read_b128 v[72:75], v64 offset:0
    ds_read_b64_tr_b16 v[8:9], v4 offset:16384
    ds_read_b64_tr_b16 v[10:11], v4 offset:16640
    ds_read_b128 v[76:79], v65 offset:0
    ds_read_b64_tr_b16 v[12:13], v4 offset:17408
    ds_read_b64_tr_b16 v[14:15], v4 offset:17664
    ds_read_b128 v[80:83], v66 offset:0
    ds_read_b64_tr_b16 v[16:17], v4 offset:18432
    ds_read_b64_tr_b16 v[18:19], v4 offset:18688
    ds_read_b128 v[84:87], v67 offset:0
    ds_read_b64_tr_b16 v[20:21], v4 offset:19456
    ds_read_b64_tr_b16 v[22:23], v4 offset:19712
    s_waitcnt lgkmcnt(9)
    v_mfma_f32_32x32x16_bf16 v[144:159], v[72:75], v[8:11], v[144:159]
    s_waitcnt lgkmcnt(6)
    v_mfma_f32_32x32x16_bf16 v[144:159], v[76:79], v[12:15], v[144:159]
    s_waitcnt lgkmcnt(3)
    v_mfma_f32_32x32x16_bf16 v[144:159], v[80:83], v[16:19], v[144:159]
    s_waitcnt lgkmcnt(0)
    v_mfma_f32_32x32x16_bf16 v[144:159], v[84:87], v[20:23], v[144:159]
    s_waitcnt vmcnt(4)
    s_barrier
    s_add_u32 m0, s47, 81920
    s_add_u32 s3, s46, 1024
    buffer_load_dwordx4 v62, s[24:27], s3 offen lds
    s_add_u32 m0, s47, 90112
    s_add_u32 s3, s46, 82944
    buffer_load_dwordx4 v62, s[24:27], s3 offen lds
    ds_read_b128 v[72:75], v64 offset:16384
    ds_read_b64_tr_b16 v[8:9], v4 offset:20480
    ds_read_b64_tr_b16 v[10:11], v4 offset:20736
    ds_read_b128 v[76:79], v65 offset:16384
    ds_read_b64_tr_b16 v[12:13], v4 offset:21504
    ds_read_b64_tr_b16 v[14:15], v4 offset:21760
    ds_read_b128 v[80:83], v66 offset:16384
    ds_read_b64_tr_b16 v[16:17], v4 offset:22528
    ds_read_b64_tr_b16 v[18:19], v4 offset:22784
    ds_read_b128 v[84:87], v67 offset:16384
    ds_read_b64_tr_b16 v[20:21], v4 offset:23552
    ds_read_b64_tr_b16 v[22:23], v4 offset:23808
    s_waitcnt lgkmcnt(9)
    v_mfma_f32_32x32x16_bf16 v[144:159], v[72:75], v[8:11], v[144:159]
    s_waitcnt lgkmcnt(6)
    v_mfma_f32_32x32x16_bf16 v[144:159], v[76:79], v[12:15], v[144:159]
    s_waitcnt lgkmcnt(3)
    v_mfma_f32_32x32x16_bf16 v[144:159], v[80:83], v[16:19], v[144:159]
    s_waitcnt lgkmcnt(0)
    v_mfma_f32_32x32x16_bf16 v[144:159], v[84:87], v[20:23], v[144:159]
    s_waitcnt vmcnt(4)
    s_barrier
    s_add_u32 m0, s47, 98304
    s_add_u32 s3, s46, 1152
    buffer_load_dwordx4 v62, s[24:27], s3 offen lds
    s_add_u32 m0, s47, 106496
    s_add_u32 s3, s46, 83072
    buffer_load_dwordx4 v62, s[24:27], s3 offen lds
    ds_read_b128 v[72:75], v64 offset:32768
    ds_read_b64_tr_b16 v[8:9], v4 offset:24576
    ds_read_b64_tr_b16 v[10:11], v4 offset:24832
    ds_read_b128 v[76:79], v65 offset:32768
    ds_read_b64_tr_b16 v[12:13], v4 offset:25600
    ds_read_b64_tr_b16 v[14:15], v4 offset:25856
    ds_read_b128 v[80:83], v66 offset:32768
    ds_read_b64_tr_b16 v[16:17], v4 offset:26624
    ds_read_b64_tr_b16 v[18:19], v4 offset:26880
    ds_read_b128 v[84:87], v67 offset:32768
    ds_read_b64_tr_b16 v[20:21], v4 offset:27648
    ds_read_b64_tr_b16 v[22:23], v4 offset:27904
    s_waitcnt lgkmcnt(9)
    v_mfma_f32_32x32x16_bf16 v[144:159], v[72:75], v[8:11], v[144:159]
    s_waitcnt lgkmcnt(6)
    v_mfma_f32_32x32x16_bf16 v[144:159], v[76:79], v[12:15], v[144:159]
    s_waitcnt lgkmcnt(3)
    v_mfma_f32_32x32x16_bf16 v[144:159], v[80:83], v[16:19], v[144:159]
    s_waitcnt lgkmcnt(0)
    v_mfma_f32_32x32x16_bf16 v[144:159], v[84:87], v[20:23], v[144:159]
    s_waitcnt vmcnt(4)
    s_barrier
    ds_read_b128 v[72:75], v64 offset:49152
    ds_read_b64_tr_b16 v[8:9], v4 offset:28672
    ds_read_b64_tr_b16 v[10:11], v4 offset:28928
    ds_read_b128 v[76:79], v65 offset:49152
    ds_read_b64_tr_b16 v[12:13], v4 offset:29696
    ds_read_b64_tr_b16 v[14:15], v4 offset:29952
    ds_read_b128 v[80:83], v66 offset:49152
    ds_read_b64_tr_b16 v[16:17], v4 offset:30720
    ds_read_b64_tr_b16 v[18:19], v4 offset:30976
    ds_read_b128 v[84:87], v67 offset:49152
    ds_read_b64_tr_b16 v[20:21], v4 offset:31744
    ds_read_b64_tr_b16 v[22:23], v4 offset:32000
    s_waitcnt lgkmcnt(9)
    v_mfma_f32_32x32x16_bf16 v[144:159], v[72:75], v[8:11], v[144:159]
    s_waitcnt lgkmcnt(6)
    v_mfma_f32_32x32x16_bf16 v[144:159], v[76:79], v[12:15], v[144:159]
    s_waitcnt lgkmcnt(3)
    v_mfma_f32_32x32x16_bf16 v[144:159], v[80:83], v[16:19], v[144:159]
    s_waitcnt lgkmcnt(0)
    v_mfma_f32_32x32x16_bf16 v[144:159], v[84:87], v[20:23], v[144:159]
    s_waitcnt vmcnt(2)
    s_barrier
    ds_read_b128 v[72:75], v64 offset:0
    ds_read_b64_tr_b16 v[8:9], v4 offset:32768
    ds_read_b64_tr_b16 v[10:11], v4 offset:33024
    ds_read_b128 v[76:79], v65 offset:0
    ds_read_b64_tr_b16 v[12:13], v4 offset:33792
    ds_read_b64_tr_b16 v[14:15], v4 offset:34048
    ds_read_b128 v[80:83], v66 offset:0
    ds_read_b64_tr_b16 v[16:17], v4 offset:34816
    ds_read_b64_tr_b16 v[18:19], v4 offset:35072
    ds_read_b128 v[84:87], v67 offset:0
    ds_read_b64_tr_b16 v[20:21], v4 offset:35840
    ds_read_b64_tr_b16 v[22:23], v4 offset:36096
    s_waitcnt lgkmcnt(9)
    v_mfma_f32_32x32x16_bf16 v[144:159], v[72:75], v[8:11], v[144:159]
    s_waitcnt lgkmcnt(6)
    v_mfma_f32_32x32x16_bf16 v[144:159], v[76:79], v[12:15], v[144:159]
    s_waitcnt lgkmcnt(3)
    v_mfma_f32_32x32x16_bf16 v[144:159], v[80:83], v[16:19], v[144:159]
    s_waitcnt lgkmcnt(0)
    v_mfma_f32_32x32x16_bf16 v[144:159], v[84:87], v[20:23], v[144:159]
    s_waitcnt vmcnt(0)
    s_barrier
    ds_read_b128 v[72:75], v64 offset:16384
    ds_read_b64_tr_b16 v[8:9], v4 offset:36864
    ds_read_b64_tr_b16 v[10:11], v4 offset:37120
    ds_read_b128 v[76:79], v65 offset:16384
    ds_read_b64_tr_b16 v[12:13], v4 offset:37888
    ds_read_b64_tr_b16 v[14:15], v4 offset:38144
    ds_read_b128 v[80:83], v66 offset:16384
    ds_read_b64_tr_b16 v[16:17], v4 offset:38912
    ds_read_b64_tr_b16 v[18:19], v4 offset:39168
    ds_read_b128 v[84:87], v67 offset:16384
    ds_read_b64_tr_b16 v[20:21], v4 offset:39936
    ds_read_b64_tr_b16 v[22:23], v4 offset:40192
    s_waitcnt lgkmcnt(9)
    v_mfma_f32_32x32x16_bf16 v[144:159], v[72:75], v[8:11], v[144:159]
    s_waitcnt lgkmcnt(6)
    v_mfma_f32_32x32x16_bf16 v[144:159], v[76:79], v[12:15], v[144:159]
    s_waitcnt lgkmcnt(3)
    v_mfma_f32_32x32x16_bf16 v[144:159], v[80:83], v[16:19], v[144:159]
    s_waitcnt lgkmcnt(0)
    v_mfma_f32_32x32x16_bf16 v[144:159], v[84:87], v[20:23], v[144:159]
    s_nop 15
    v_and_b32 v23, 31, v0
    v_cmp_eq_u32 vcc, 20, v23
    v_cvt_pk_bf16_f32 v24, v144, v145
    v_cvt_pk_bf16_f32 v25, v146, v147
    v_cvt_pk_bf16_f32 v26, v148, v149
    v_cvt_pk_bf16_f32 v27, v150, v151
    v_cvt_pk_bf16_f32 v28, v152, v153
    v_cvt_pk_bf16_f32 v29, v154, v155
    v_cvt_pk_bf16_f32 v30, v156, v157
    v_cvt_pk_bf16_f32 v31, v158, v159
    v_cndmask_b32 v24, v24, v60, vcc
    v_cndmask_b32 v25, v25, v60, vcc
    v_cndmask_b32 v26, v26, v60, vcc
    v_cndmask_b32 v27, v27, v60, vcc
    v_cndmask_b32 v28, v28, v60, vcc
    v_cndmask_b32 v29, v29, v60, vcc
    v_cndmask_b32 v30, v30, v60, vcc
    v_cndmask_b32 v31, v31, v60, vcc
    buffer_store_dwordx4 v[24:27], v1, s[28:31], s48 offen offset:1536 sc1
    buffer_store_dwordx4 v[28:31], v1, s[28:31], s48 offen offset:2560 sc1
    s_mov_b64 exec, -1
    s_branch P1_DONE
K1_HELP:
    s_sub_u32 s20, s20, 8
    s_mov_b32 s48, s60
    s_mov_b32 s49, s61
    s_mov_b32 s50, 819200
    s_mov_b32 s51, 0x00020000
    s_mov_b32 s52, s62
    s_mov_b32 s53, s63
    s_mov_b32 s54, 1966080
    s_mov_b32 s55, 0x00020000
    s_lshl_b32 s3, s2, 2
    s_add_u32 s3, s3, s20
    s_lshl_b32 s3, s3, 10
    s_add_u32 s44, s3, 0x100000
    s_add_u32 s45, s3, 0x200000
    v_lshlrev_b32 v1, 4, v0
    s_mov_b32 s68, s64
    s_mov_b32 s69, s65
    s_mov_b32 s70, 256
    s_mov_b32 s71, 0x00020000
    v_mov_b32 v2, 0
    s_or_b32 s46, s2, s20
    s_cmp_lg_u32 s46, 0
    s_cbranch_scc1 K1_T0
    s_memrealtime s[46:47]
    s_waitcnt lgkmcnt(0)
    s_or_b32 s46, s46, 1
    v_mov_b32 v3, s46
    s_mov_b64 exec, 1
    buffer_store_dword v3, v2, s[68:71], 0 offen sc1
    s_mov_b64 exec, -1
K1_T0:
    s_cmp_eq_u32 s56, 0
    s_cbranch_scc1 K1_HC
    s_lshl_b32 s41, s40, 2
    s_lshl_b32 s42, s40, 3
    s_add_u32 s43, s41, s42
    s_lshl_b32 s58, s40, 6
    s_lshl_b32 s59, s40, 4
    s_mul_i32 s59, s59, s20
    s_mul_i32 s46, s22, 163840
    s_lshl_b32 s47, s20, 10
    s_lshl_b32 s72, s20, 12
    s_add_u32 s72, s72, 16384
    s_and_b32 s73, s20, 1
    v_lshrrev_b32 v13, 3, v0
    s_lshl_b32 s74, s20, 3
    v_add_u32 v13, s74, v13
    v_mul_u32_u24 v13, 0x500, v13
    v_lshrrev_b32 v14, 4, v0
    s_lshl_b32 s74, s73, 2
    v_add_u32 v14, s74, v14
    v_and_b32 v14, 7, v14
    v_and_b32 v15, 7, v0
    v_xor_b32 v14, v14, v15
    v_lshl_add_u32 v16, v14, 4, v13
    v_lshrrev_b32 v14, 4, v0
    v_mul_lo_u32 v13, v14, s40
    v_lshlrev_b32 v14, 2, v14
    v_and_b32 v15, 15, v0
    v_xor_b32 v14, v14, v15
    v_lshl_add_u32 v17, v14, 4, v13
    s_barrier
    s_add_u32 m0, s47, 0
    s_add_u32 s74, s46, 0
    buffer_load_dwordx4 v16, s[24:27], s74 offen lds
    s_add_u32 m0, s47, 4096
    s_add_u32 s74, s46, 40960
    buffer_load_dwordx4 v16, s[24:27], s74 offen lds
    s_add_u32 m0, s47, 8192
    s_add_u32 s74, s46, 81920
    buffer_load_dwordx4 v16, s[24:27], s74 offen lds
    s_add_u32 m0, s47, 12288
    s_add_u32 s74, s46, 122880
    buffer_load_dwordx4 v16, s[24:27], s74 offen lds
    s_add_u32 m0, s72, 0
    s_mov_b32 s74, s59
    buffer_load_dwordx4 v17, s[32:35], s74 offen lds
    s_add_u32 m0, s72, 16384
    s_mov_b32 s74, s59
    buffer_load_dwordx4 v17, s[36:39], s74 offen lds
    s_add_u32 m0, s72, 1024
    s_add_u32 s74, s59, s41
    buffer_load_dwordx4 v17, s[32:35], s74 offen lds
    s_add_u32 m0, s72, 17408
    s_add_u32 s74, s59, s41
    buffer_load_dwordx4 v17, s[36:39], s74 offen lds
    s_add_u32 m0, s72, 2048
    s_add_u32 s74, s59, s42
    buffer_load_dwordx4 v17, s[32:35], s74 offen lds
    s_add_u32 m0, s72, 18432
    s_add_u32 s74, s59, s42
    buffer_load_dwordx4 v17, s[36:39], s74 offen lds
    s_add_u32 m0, s72, 3072
    s_add_u32 s74, s59, s43
    buffer_load_dwordx4 v17, s[32:35], s74 offen lds
    s_add_u32 m0, s72, 19456
    s_add_u32 s74, s59, s43
    buffer_load_dwordx4 v17, s[36:39], s74 offen lds
    s_add_u32 s59, s59, s58
    s_add_u32 m0, s47, 49152
    s_add_u32 s74, s46, 128
    buffer_load_dwordx4 v16, s[24:27], s74 offen lds
    s_add_u32 m0, s47, 53248
    s_add_u32 s74, s46, 41088
    buffer_load_dwordx4 v16, s[24:27], s74 offen lds
    s_add_u32 m0, s47, 57344
    s_add_u32 s74, s46, 82048
    buffer_load_dwordx4 v16, s[24:27], s74 offen lds
    s_add_u32 m0, s47, 61440
    s_add_u32 s74, s46, 123008
    buffer_load_dwordx4 v16, s[24:27], s74 offen lds
    s_add_u32 m0, s72, 49152
    s_mov_b32 s74, s59
    buffer_load_dwordx4 v17, s[32:35], s74 offen lds
    s_add_u32 m0, s72, 65536
    s_mov_b32 s74, s59
    buffer_load_dwordx4 v17, s[36:39], s74 offen lds
    s_add_u32 m0, s72, 50176
    s_add_u32 s74, s59, s41
    buffer_load_dwordx4 v17, s[32:35], s74 offen lds
    s_add_u32 m0, s72, 66560
    s_add_u32 s74, s59, s41
    buffer_load_dwordx4 v17, s[36:39], s74 offen lds
    s_add_u32 m0, s72, 51200
    s_add_u32 s74, s59, s42
    buffer_load_dwordx4 v17, s[32:35], s74 offen lds
    s_add_u32 m0, s72, 67584
    s_add_u32 s74, s59, s42
    buffer_load_dwordx4 v17, s[36:39], s74 offen lds
    s_add_u32 m0, s72, 52224
    s_add_u32 s74, s59, s43
    buffer_load_dwordx4 v17, s[32:35], s74 offen lds
    s_add_u32 m0, s72, 68608
    s_add_u32 s74, s59, s43
    buffer_load_dwordx4 v17, s[36:39], s74 offen lds
    s_add_u32 s59, s59, s58
    s_waitcnt vmcnt(12)
    s_barrier
    s_add_u32 m0, s47, 98304
    s_add_u32 s74, s46, 256
    buffer_load_dwordx4 v16, s[24:27], s74 offen lds
    s_add_u32 m0, s47, 102400
    s_add_u32 s74, s46, 41216
    buffer_load_dwordx4 v16, s[24:27], s74 offen lds
    s_add_u32 m0, s47, 106496
    s_add_u32 s74, s46, 82176
    buffer_load_dwordx4 v16, s[24:27], s74 offen lds
    s_add_u32 m0, s47, 110592
    s_add_u32 s74, s46, 123136
    buffer_load_dwordx4 v16, s[24:27], s74 offen lds
    s_add_u32 m0, s72, 98304
    s_mov_b32 s74, s59
    buffer_load_dwordx4 v17, s[32:35], s74 offen lds
    s_add_u32 m0, s72, 114688
    s_mov_b32 s74, s59
    buffer_load_dwordx4 v17, s[36:39], s74 offen lds
    s_add_u32 m0, s72, 99328
    s_add_u32 s74, s59, s41
    buffer_load_dwordx4 v17, s[32:35], s74 offen lds
    s_add_u32 m0, s72, 115712
    s_add_u32 s74, s59, s41
    buffer_load_dwordx4 v17, s[36:39], s74 offen lds
    s_add_u32 m0, s72, 100352
    s_add_u32 s74, s59, s42
    buffer_load_dwordx4 v17, s[32:35], s74 offen lds
    s_add_u32 m0, s72, 116736
    s_add_u32 s74, s59, s42
    buffer_load_dwordx4 v17, s[36:39], s74 offen lds
    s_add_u32 m0, s72, 101376
    s_add_u32 s74, s59, s43
    buffer_load_dwordx4 v17, s[32:35], s74 offen lds
    s_add_u32 m0, s72, 117760
    s_add_u32 s74, s59, s43
    buffer_load_dwordx4 v17, s[36:39], s74 offen lds
    s_add_u32 s59, s59, s58
    s_waitcnt vmcnt(12)
    s_barrier
    s_add_u32 m0, s47, 0
    s_add_u32 s74, s46, 384
    buffer_load_dwordx4 v16, s[24:27], s74 offen lds
    s_add_u32 m0, s47, 4096
    s_add_u32 s74, s46, 41344
    buffer_load_dwordx4 v16, s[24:27], s74 offen lds
    s_add_u32 m0, s47, 8192
    s_add_u32 s74, s46, 82304
    buffer_load_dwordx4 v16, s[24:27], s74 offen lds
    s_add_u32 m0, s47, 12288
    s_add_u32 s74, s46, 123264
    buffer_load_dwordx4 v16, s[24:27], s74 offen lds
    s_add_u32 m0, s72, 0
    s_mov_b32 s74, s59
    buffer_load_dwordx4 v17, s[32:35], s74 offen lds
    s_add_u32 m0, s72, 16384
    s_mov_b32 s74, s59
    buffer_load_dwordx4 v17, s[36:39], s74 offen lds
    s_add_u32 m0, s72, 1024
    s_add_u32 s74, s59, s41
    buffer_load_dwordx4 v17, s[32:35], s74 offen lds
    s_add_u32 m0, s72, 17408
    s_add_u32 s74, s59, s41
    buffer_load_dwordx4 v17, s[36:39], s74 offen lds
    s_add_u32 m0, s72, 2048
    s_add_u32 s74, s59, s42
    buffer_load_dwordx4 v17, s[32:35], s74 offen lds
    s_add_u32 m0, s72, 18432
    s_add_u32 s74, s59, s42
    buffer_load_dwordx4 v17, s[36:39], s74 offen lds
    s_add_u32 m0, s72, 3072
    s_add_u32 s74, s59, s43
    buffer_load_dwordx4 v17, s[32:35], s74 offen lds
    s_add_u32 m0, s72, 19456
    s_add_u32 s74, s59, s43
    buffer_load_dwordx4 v17, s[36:39], s74 offen lds
    s_add_u32 s59, s59, s58
    s_waitcnt vmcnt(12)
    s_barrier
    s_add_u32 m0, s47, 49152
    s_add_u32 s74, s46, 512
    buffer_load_dwordx4 v16, s[24:27], s74 offen lds
    s_add_u32 m0, s47, 53248
    s_add_u32 s74, s46, 41472
    buffer_load_dwordx4 v16, s[24:27], s74 offen lds
    s_add_u32 m0, s47, 57344
    s_add_u32 s74, s46, 82432
    buffer_load_dwordx4 v16, s[24:27], s74 offen lds
    s_add_u32 m0, s47, 61440
    s_add_u32 s74, s46, 123392
    buffer_load_dwordx4 v16, s[24:27], s74 offen lds
    s_add_u32 m0, s72, 49152
    s_mov_b32 s74, s59
    buffer_load_dwordx4 v17, s[32:35], s74 offen lds
    s_add_u32 m0, s72, 65536
    s_mov_b32 s74, s59
    buffer_load_dwordx4 v17, s[36:39], s74 offen lds
    s_add_u32 m0, s72, 50176
    s_add_u32 s74, s59, s41
    buffer_load_dwordx4 v17, s[32:35], s74 offen lds
    s_add_u32 m0, s72, 66560
    s_add_u32 s74, s59, s41
    buffer_load_dwordx4 v17, s[36:39], s74 offen lds
    s_add_u32 m0, s72, 51200
    s_add_u32 s74, s59, s42
    buffer_load_dwordx4 v17, s[32:35], s74 offen lds
    s_add_u32 m0, s72, 67584
    s_add_u32 s74, s59, s42
    buffer_load_dwordx4 v17, s[36:39], s74 offen lds
    s_add_u32 m0, s72, 52224
    s_add_u32 s74, s59, s43
    buffer_load_dwordx4 v17, s[32:35], s74 offen lds
    s_add_u32 m0, s72, 68608
    s_add_u32 s74, s59, s43
    buffer_load_dwordx4 v17, s[36:39], s74 offen lds
    s_add_u32 s59, s59, s58
    buffer_load_dwordx4 v[4:7], v1, s[52:55], s3 offen
    buffer_load_dwordx4 v[8:11], v1, s[52:55], s44 offen
    buffer_load_dwordx4 v[20:23], v1, s[48:51], s3 offen
    s_waitcnt vmcnt(15)
    s_barrier
    s_add_u32 m0, s47, 98304
    s_add_u32 s74, s46, 640
    buffer_load_dwordx4 v16, s[24:27], s74 offen lds
    s_add_u32 m0, s47, 102400
    s_add_u32 s74, s46, 41600
    buffer_load_dwordx4 v16, s[24:27], s74 offen lds
    s_add_u32 m0, s47, 106496
    s_add_u32 s74, s46, 82560
    buffer_load_dwordx4 v16, s[24:27], s74 offen lds
    s_add_u32 m0, s47, 110592
    s_add_u32 s74, s46, 123520
    buffer_load_dwordx4 v16, s[24:27], s74 offen lds
    s_add_u32 m0, s72, 98304
    s_mov_b32 s74, s59
    buffer_load_dwordx4 v17, s[32:35], s74 offen lds
    s_add_u32 m0, s72, 114688
    s_mov_b32 s74, s59
    buffer_load_dwordx4 v17, s[36:39], s74 offen lds
    s_add_u32 m0, s72, 99328
    s_add_u32 s74, s59, s41
    buffer_load_dwordx4 v17, s[32:35], s74 offen lds
    s_add_u32 m0, s72, 115712
    s_add_u32 s74, s59, s41
    buffer_load_dwordx4 v17, s[36:39], s74 offen lds
    s_add_u32 m0, s72, 100352
    s_add_u32 s74, s59, s42
    buffer_load_dwordx4 v17, s[32:35], s74 offen lds
    s_add_u32 m0, s72, 116736
    s_add_u32 s74, s59, s42
    buffer_load_dwordx4 v17, s[36:39], s74 offen lds
    s_add_u32 m0, s72, 101376
    s_add_u32 s74, s59, s43
    buffer_load_dwordx4 v17, s[32:35], s74 offen lds
    s_add_u32 m0, s72, 117760
    s_add_u32 s74, s59, s43
    buffer_load_dwordx4 v17, s[36:39], s74 offen lds
    s_add_u32 s59, s59, s58
    s_waitcnt vmcnt(15)
    s_barrier
    s_add_u32 m0, s47, 0
    s_add_u32 s74, s46, 768
    buffer_load_dwordx4 v16, s[24:27], s74 offen lds
    s_add_u32 m0, s47, 4096
    s_add_u32 s74, s46, 41728
    buffer_load_dwordx4 v16, s[24:27], s74 offen lds
    s_add_u32 m0, s47, 8192
    s_add_u32 s74, s46, 82688
    buffer_load_dwordx4 v16, s[24:27], s74 offen lds
    s_add_u32 m0, s47, 12288
    s_add_u32 s74, s46, 123648
    buffer_load_dwordx4 v16, s[24:27], s74 offen lds
    s_add_u32 m0, s72, 0
    s_mov_b32 s74, s59
    buffer_load_dwordx4 v17, s[32:35], s74 offen lds
    s_add_u32 m0, s72, 16384
    s_mov_b32 s74, s59
    buffer_load_dwordx4 v17, s[36:39], s74 offen lds
    s_add_u32 m0, s72, 1024
    s_add_u32 s74, s59, s41
    buffer_load_dwordx4 v17, s[32:35], s74 offen lds
    s_add_u32 m0, s72, 17408
    s_add_u32 s74, s59, s41
    buffer_load_dwordx4 v17, s[36:39], s74 offen lds
    s_add_u32 m0, s72, 2048
    s_add_u32 s74, s59, s42
    buffer_load_dwordx4 v17, s[32:35], s74 offen lds
    s_add_u32 m0, s72, 18432
    s_add_u32 s74, s59, s42
    buffer_load_dwordx4 v17, s[36:39], s74 offen lds
    s_add_u32 m0, s72, 3072
    s_add_u32 s74, s59, s43
    buffer_load_dwordx4 v17, s[32:35], s74 offen lds
    s_add_u32 m0, s72, 19456
    s_add_u32 s74, s59, s43
    buffer_load_dwordx4 v17, s[36:39], s74 offen lds
    s_add_u32 s59, s59, s58
    s_waitcnt vmcnt(12)
    s_barrier
    s_add_u32 m0, s47, 49152
    s_add_u32 s74, s46, 896
    buffer_load_dwordx4 v16, s[24:27], s74 offen lds
    s_add_u32 m0, s47, 53248
    s_add_u32 s74, s46, 41856
    buffer_load_dwordx4 v16, s[24:27], s74 offen lds
    s_add_u32 m0, s47, 57344
    s_add_u32 s74, s46, 82816
    buffer_load_dwordx4 v16, s[24:27], s74 offen lds
    s_add_u32 m0, s47, 61440
    s_add_u32 s74, s46, 123776
    buffer_load_dwordx4 v16, s[24:27], s74 offen lds
    s_add_u32 m0, s72, 49152
    s_mov_b32 s74, s59
    buffer_load_dwordx4 v17, s[32:35], s74 offen lds
    s_add_u32 m0, s72, 65536
    s_mov_b32 s74, s59
    buffer_load_dwordx4 v17, s[36:39], s74 offen lds
    s_add_u32 m0, s72, 50176
    s_add_u32 s74, s59, s41
    buffer_load_dwordx4 v17, s[32:35], s74 offen lds
    s_add_u32 m0, s72, 66560
    s_add_u32 s74, s59, s41
    buffer_load_dwordx4 v17, s[36:39], s74 offen lds
    s_add_u32 m0, s72, 51200
    s_add_u32 s74, s59, s42
    buffer_load_dwordx4 v17, s[32:35], s74 offen lds
    s_add_u32 m0, s72, 67584
    s_add_u32 s74, s59, s42
    buffer_load_dwordx4 v17, s[36:39], s74 offen lds
    s_add_u32 m0, s72, 52224
    s_add_u32 s74, s59, s43
    buffer_load_dwordx4 v17, s[32:35], s74 offen lds
    s_add_u32 m0, s72, 68608
    s_add_u32 s74, s59, s43
    buffer_load_dwordx4 v17, s[36:39], s74 offen lds
    s_add_u32 s59, s59, s58
    s_waitcnt vmcnt(12)
    s_barrier
    s_add_u32 m0, s47, 98304
    s_add_u32 s74, s46, 1024
    buffer_load_dwordx4 v16, s[24:27], s74 offen lds
    s_add_u32 m0, s47, 102400
    s_add_u32 s74, s46, 41984
    buffer_load_dwordx4 v16, s[24:27], s74 offen lds
    s_add_u32 m0, s47, 106496
    s_add_u32 s74, s46, 82944
    buffer_load_dwordx4 v16, s[24:27], s74 offen lds
    s_add_u32 m0, s47, 110592
    s_add_u32 s74, s46, 123904
    buffer_load_dwordx4 v16, s[24:27], s74 offen lds
    s_add_u32 m0, s72, 98304
    s_mov_b32 s74, s59
    buffer_load_dwordx4 v17, s[32:35], s74 offen lds
    s_add_u32 m0, s72, 114688
    s_mov_b32 s74, s59
    buffer_load_dwordx4 v17, s[36:39], s74 offen lds
    s_add_u32 m0, s72, 99328
    s_add_u32 s74, s59, s41
    buffer_load_dwordx4 v17, s[32:35], s74 offen lds
    s_add_u32 m0, s72, 115712
    s_add_u32 s74, s59, s41
    buffer_load_dwordx4 v17, s[36:39], s74 offen lds
    s_add_u32 m0, s72, 100352
    s_add_u32 s74, s59, s42
    buffer_load_dwordx4 v17, s[32:35], s74 offen lds
    s_add_u32 m0, s72, 116736
    s_add_u32 s74, s59, s42
    buffer_load_dwordx4 v17, s[36:39], s74 offen lds
    s_add_u32 m0, s72, 101376
    s_add_u32 s74, s59, s43
    buffer_load_dwordx4 v17, s[32:35], s74 offen lds
    s_add_u32 m0, s72, 117760
    s_add_u32 s74, s59, s43
    buffer_load_dwordx4 v17, s[36:39], s74 offen lds
    s_add_u32 s59, s59, s58
    s_waitcnt vmcnt(12)
    s_barrier
    s_add_u32 m0, s47, 0
    s_add_u32 s74, s46, 1152
    buffer_load_dwordx4 v16, s[24:27], s74 offen lds
    s_add_u32 m0, s47, 4096
    s_add_u32 s74, s46, 42112
    buffer_load_dwordx4 v16, s[24:27], s74 offen lds
    s_add_u32 m0, s47, 8192
    s_add_u32 s74, s46, 83072
    buffer_load_dwordx4 v16, s[24:27], s74 offen lds
    s_add_u32 m0, s47, 12288
    s_add_u32 s74, s46, 124032
    buffer_load_dwordx4 v16, s[24:27], s74 offen lds
    s_add_u32 m0, s72, 0
    s_mov_b32 s74, s59
    buffer_load_dwordx4 v17, s[32:35], s74 offen lds
    s_add_u32 m0, s72, 16384
    s_mov_b32 s74, s59
    buffer_load_dwordx4 v17, s[36:39], s74 offen lds
    s_add_u32 m0, s72, 1024
    s_add_u32 s74, s59, s41
    buffer_load_dwordx4 v17, s[32:35], s74 offen lds
    s_add_u32 m0, s72, 17408
    s_add_u32 s74, s59, s41
    buffer_load_dwordx4 v17, s[36:39], s74 offen lds
    s_add_u32 m0, s72, 2048
    s_add_u32 s74, s59, s42
    buffer_load_dwordx4 v17, s[32:35], s74 offen lds
    s_add_u32 m0, s72, 18432
    s_add_u32 s74, s59, s42
    buffer_load_dwordx4 v17, s[36:39], s74 offen lds
    s_add_u32 m0, s72, 3072
    s_add_u32 s74, s59, s43
    buffer_load_dwordx4 v17, s[32:35], s74 offen lds
    s_add_u32 m0, s72, 19456
    s_add_u32 s74, s59, s43
    buffer_load_dwordx4 v17, s[36:39], s74 offen lds
    s_add_u32 s59, s59, s58
    s_waitcnt vmcnt(12)
    s_barrier
    s_waitcnt vmcnt(0)
    s_branch K1_HD
K1_HC:
    s_mov_b32 s32, s12
    s_mov_b32 s33, s13
    s_mov_b32 s34, 1966080
    s_mov_b32 s35, 0x00020000
    s_mov_b32 s36, s14
    s_mov_b32 s37, s15
    s_mov_b32 s38, 1966080
    s_mov_b32 s39, 0x00020000
    s_mov_b32 s40, s6
    s_mov_b32 s41, s7
    s_mov_b32 s42, 819200
    s_mov_b32 s43, 0x00020000
    s_barrier
    buffer_load_dwordx4 v[4:7], v1, s[24:27], s3 offen
    buffer_load_dwordx4 v[4:7], v1, s[32:35], s3 offen
    buffer_load_dwordx4 v[4:7], v1, s[36:39], s3 offen
    buffer_load_dwordx4 v[4:7], v1, s[24:27], s44 offen
    buffer_load_dwordx4 v[4:7], v1, s[24:27], s45 offen
    buffer_load_dwordx4 v[4:7], v1, s[40:43], s3 offen
    buffer_load_dwordx4 v[4:7], v1, s[32:35], s44 offen
    buffer_load_dwordx4 v[4:7], v1, s[36:39], s44 offen
    s_barrier
    s_barrier
    s_barrier
    s_barrier
    s_barrier
    s_barrier
    buffer_load_dwordx4 v[4:7], v1, s[52:55], s3 offen
    buffer_load_dwordx4 v[8:11], v1, s[52:55], s44 offen
    buffer_load_dwordx4 v[12:15], v1, s[48:51], s3 offen
    s_barrier
    s_barrier
    s_barrier
K1_HD:
    s_cmp_lg_u32 s20, 0
    s_cbranch_scc1 K1_T5
    s_mov_b32 s47, 0
K1_T4:
    buffer_load_dword v3, v2, s[68:71], 0 offen sc1
    s_waitcnt vmcnt(0)
    v_readfirstlane_b32 s46, v3
    s_add_u32 s47, s47, 1
    s_cmp_ge_u32 s47, 0x100000
    s_cbranch_scc1 K1_T6
    s_cmp_eq_u32 s46, 0
    s_cbranch_scc1 K1_T4
K1_T6:
    v_mov_b32 v2, 159744
    ds_write_b32 v2, v3 offset:8
    s_waitcnt lgkmcnt(0)
K1_T5:
    s_and_b32 s47, s2, 7
    s_lshl_b32 s47, s47, 3
    s_lshr_b32 s74, s2, 5
    s_add_u32 s47, s47, s74
    v_lshl_add_u32 v5, v0, 4, 15
    s_lshr_b32 s47, s47, 2
    s_lshl_b32 s47, s47, 4
    s_sub_u32 s47, s47, 4
    v_add_u32 v6, s47, v0
    v_cmp_gt_u32 vcc, 16, v0
    s_nop 1
    v_cndmask_b32 v5, v6, v5, vcc
    v_lshlrev_b32 v5, 7, v5
    v_mov_b32 v2, 159744
    s_barrier
    s_barrier
    s_cmp_lg_u32 s20, 0
    s_cbranch_scc1 P1_DONE
    s_mov_b32 s47, 3014656
    s_mov_b64 exec, 0x7ffff
    v_mov_b32 v7, 1
    buffer_load_dword v6, v5, s[28:31], s47 offen sc1
    s_waitcnt vmcnt(0)
    v_cmp_ne_u32 vcc, s46, v6
    s_nop 1
    s_cbranch_vccz K1_RDY
    buffer_load_dword v6, v5, s[28:31], s47 offen sc1
    s_waitcnt vmcnt(0)
    v_cmp_ne_u32 vcc, s46, v6
    s_nop 1
    s_cbranch_vccz K1_RDY
    v_mov_b32 v7, 0
K1_RDY:
    s_mov_b64 exec, 1
    ds_write_b32 v2, v7 offset:12
    s_mov_b64 exec, -1
    s_waitcnt lgkmcnt(0)
P1_DONE:
    s_waitcnt vmcnt(0)
    s_barrier
    s_lshl_b32 s76, s22, 4
    s_add_u32 s76, s76, s23
    s_mov_b64 s[4:5], s[62:63]
    s_mov_b64 s[6:7], s[18:19]
    s_mov_b64 s[8:9], s[60:61]
    s_mov_b64 s[12:13], s[66:67]
    s_mov_b64 s[14:15], s[64:65]
    s_mov_b32 s20, s79
    v_mov_b32 v14, 159744
    ds_read_b64 v[2:3], v14 offset:8
    s_and_b32 s21, s2, 7
    s_lshl_b32 s21, s21, 3
    s_lshr_b32 s22, s2, 5
    s_add_u32 s21, s21, s22
    s_bfe_u32 s22, s2, 0x20003
    s_waitcnt lgkmcnt(0)
    s_mov_b32 s28, s6
    s_mov_b32 s29, s7
    s_mov_b32 s30, 18874368
    s_mov_b32 s31, 0x00020000
    v_readfirstlane_b32 s77, v2
    v_readfirstlane_b32 s75, v3
    s_cmp_ge_u32 s20, 8
    s_cbranch_scc1 K2_GEMM
    v_lshl_add_u32 v113, v0, 4, 15
    s_lshr_b32 s3, s21, 2
    s_lshl_b32 s3, s3, 4
    s_sub_u32 s3, s3, 4
    v_add_u32 v112, s3, v0
    v_cmp_gt_u32 vcc, 16, v0
    s_nop 1
    v_cndmask_b32 v113, v112, v113, vcc
    v_lshlrev_b32 v113, 7, v113
    s_cmp_eq_u32 s75, 1
    s_cbranch_scc1 K2_PX2
    s_cmp_lg_u32 s20, 7
    s_cbranch_scc1 K2_PX
    s_mov_b32 s3, 3014656
    s_mov_b32 s63, 0
    s_mov_b64 exec, 0xffff
K2_PLa:
    buffer_load_dword v112, v113, s[28:31], s3 offen sc1
    s_waitcnt vmcnt(0)
    v_cmp_ne_u32 vcc, s77, v112
    s_nop 1
    s_cbranch_vccz K2_PDa
    s_sleep 1
    s_add_u32 s63, s63, 1
    s_cmp_lt_u32 s63, 0x100000
    s_cbranch_scc1 K2_PLa
K2_PDa:
    s_mov_b64 exec, -1
K2_PX:
    s_barrier
K2_PX2:
    s_lshl_b32 s23, s22, 3
    s_add_u32 s23, s23, s20
    s_mul_i32 s3, s23, 81920
    s_lshl_b32 s24, s21, 8
    s_add_u32 s3, s3, s24
    v_and_b32 v1, 31, v0
    v_lshlrev_b32 v1, 3, v1
    v_lshrrev_b32 v2, 5, v0
    v_lshl_add_u32 v2, v2, 14, v1
    s_add_u32 s24, s3, 32768
    s_add_u32 s25, s3, 65536
    s_mov_b32 s41, s3
    s_mov_b32 s42, s24
    s_mov_b32 s43, s25
    v_lshlrev_b32 v3, 4, v0
    v_lshlrev_b32 v4, 3, v0
    s_lshl_b32 s26, s20, 11
    s_add_u32 s27, s26, 2621440
    s_mov_b32 s36, s26
    s_mov_b32 s37, s27
    s_cmp_eq_u32 s20, 7
    s_cbranch_scc1 K2_SKa
    s_mov_b32 m0, s36
    s_add_u32 s3, s37, 1024
    buffer_load_dwordx4 v3, s[28:31], s37 offen sc1 lds
    s_add_u32 m0, s36, 1024
    s_nop 0
    buffer_load_dwordx4 v3, s[28:31], s3 offen sc1 lds
K2_SKa:
    s_add_u32 s37, s37, 14336
    s_add_u32 s36, s36, 14336
    s_cmp_ge_u32 s36, 57344
    s_cselect_b32 s3, 57344, 0
    s_sub_u32 s36, s36, s3
    s_cmp_eq_u32 s20, 7
    s_cbranch_scc1 K2_SKb
    s_mov_b32 m0, s36
    s_add_u32 s3, s37, 1024
    buffer_load_dwordx4 v3, s[28:31], s37 offen sc1 lds
    s_add_u32 m0, s36, 1024
    s_nop 0
    buffer_load_dwordx4 v3, s[28:31], s3 offen sc1 lds
K2_SKb:
    s_add_u32 s37, s37, 14336
    s_add_u32 s36, s36, 14336
    s_cmp_ge_u32 s36, 57344
    s_cselect_b32 s3, 57344, 0
    s_sub_u32 s36, s36, s3
    s_cmp_eq_u32 s20, 7
    s_cbranch_scc1 K2_SKc
    s_mov_b32 m0, s36
    s_add_u32 s3, s37, 1024
    buffer_load_dwordx4 v3, s[28:31], s37 offen sc1 lds
    s_add_u32 m0, s36, 1024
    s_nop 0
    buffer_load_dwordx4 v3, s[28:31], s3 offen sc1 lds
K2_SKc:
    s_add_u32 s37, s37, 14336
    s_add_u32 s36, s36, 14336
    s_cmp_ge_u32 s36, 57344
    s_cselect_b32 s3, 57344, 0
    s_sub_u32 s36, s36, s3
    s_cmp_eq_u32 s75, 1
    s_cbranch_scc1 K2_PY2
    s_cmp_lg_u32 s20, 7
    s_cbranch_scc1 K2_PY
    s_mov_b32 s3, 3014656
    s_mov_b32 s63, 0
    s_mov_b64 exec, 0x70000
K2_PLb:
    buffer_load_dword v112, v113, s[28:31], s3 offen sc1
    s_waitcnt vmcnt(0)
    v_cmp_ne_u32 vcc, s77, v112
    s_nop 1
    s_cbranch_vccz K2_PDb
    s_sleep 1
    s_add_u32 s63, s63, 1
    s_cmp_lt_u32 s63, 0x100000
    s_cbranch_scc1 K2_PLb
K2_PDb:
    s_mov_b64 exec, -1
K2_PY:
    s_barrier
K2_PY2:
    buffer_load_dwordx2 v[72:73], v2, s[28:31], s41 offen sc1
    buffer_load_dwordx2 v[74:75], v2, s[28:31], s42 offen sc1
    buffer_load_dwordx2 v[76:77], v1, s[28:31], s43 offen sc1
    v_lshrrev_b32 v13, 1, v1
    s_lshl_b32 s24, s21, 7
    s_add_u32 s24, s24, 2883584
    buffer_load_dword v13, v13, s[28:31], s24 offen sc1
    v_mov_b32 v86, 0
    v_mov_b32 v87, 0
    v_mov_b32 v94, 0
    v_mov_b32 v95, 0
    v_mov_b32 v78, 0
    v_mov_b32 v79, 0
    v_mov_b32 v68, 0
    v_mov_b32 v69, 0
    v_mov_b32 v70, 0
    v_mov_b32 v71, 0
    v_mov_b32 v108, 0
    v_mov_b32 v109, 0
    v_mov_b32 v110, 0
    v_mov_b32 v111, 0
    v_mov_b32 v48, 0
    v_mov_b32 v49, 0
    v_mov_b32 v50, 0
    v_mov_b32 v51, 0
    v_mov_b32 v52, 0
    v_mov_b32 v53, 0
    v_mov_b32 v54, 0
    v_mov_b32 v55, 0
    v_mov_b32 v56, 0
    v_mov_b32 v57, 0
    v_mov_b32 v58, 0
    v_mov_b32 v59, 0
    v_mov_b32 v60, 0
    v_mov_b32 v61, 0
    v_mov_b32 v62, 0
    v_mov_b32 v63, 0
    v_cmp_le_u32 s[32:33], 32, v0
    v_mov_b32 v8, v3
    v_mov_b32 v9, v4
    v_add_u32 v10, 14336, v3
    v_add_u32 v11, 14336, v4
    s_mov_b32 s38, 28672
    v_mov_b32 v14, 159744
    v_mov_b32 v15, 1
    v_mov_b32 v6, 0
    v_mov_b32 v7, 0
    ds_write_b64 v14, v[6:7]
    s_mov_b32 s40, 8
    s_waitcnt lgkmcnt(0)
    s_waitcnt vmcnt(0)
    s_barrier
    v_cndmask_b32 v76, v76, 0, s[32:33]
    v_cndmask_b32 v77, v77, 0, s[32:33]
    ds_read_b128 v[80:83], v8 offset:0
    ds_read_b64 v[84:85], v9 offset:1024
    ds_read_b128 v[88:91], v8 offset:3584
    ds_read_b64 v[92:93], v9 offset:4608
    ds_read_b128 v[96:99], v8 offset:1536
    ds_read_b128 v[100:103], v8 offset:2560
    s_waitcnt lgkmcnt(0)
    v_mfma_f32_32x32x16_bf16 v[16:31], v[80:83], v[72:75], 0
    v_mfma_f32_32x32x8_bf16 v[16:31], v[84:85], v[76:77], v[16:31]
    s_nop 15
    v_max3_f32 v5, v16, v17, v18
    v_max3_f32 v5, v5, v19, v20
    v_max3_f32 v5, v5, v21, v22
    v_max3_f32 v5, v5, v23, v24
    v_max3_f32 v5, v5, v25, v26
    v_max3_f32 v5, v5, v27, v28
    v_max3_f32 v5, v5, v29, v30
    v_max_f32 v5, v5, v31
    v_mov_b32 v6, v5
    s_nop 1
    v_permlane32_swap_b32 v5, v6
    s_nop 1
    v_max_f32 v5, v5, v6
    v_sub_f32 v5, 0, v5
    v_cvt_pk_bf16_f32 v6, v5, v5
    v_lshlrev_b32 v6, 16, v6
    v_sub_f32 v6, v5, v6
    v_cvt_pk_bf16_f32 v6, v5, v6
    v_cndmask_b32 v76, v76, v6, s[32:33]
    s_nop 1
    v_mfma_f32_32x32x16_bf16 v[16:31], v[80:83], v[72:75], 0
    v_mfma_f32_32x32x8_bf16 v[16:31], v[84:85], v[76:77], v[16:31]
    s_mov_b32 s39, 0
    s_nop 7
    v_mov_b32 v44, 0
    v_mov_b32 v45, 0
    v_mov_b32 v46, 0
    v_mov_b32 v47, 0
.p2align 6
K2_LOOP:
    s_setprio 1
    s_waitcnt vmcnt(2) lgkmcnt(0)
    s_mov_b64 exec, 1
    ds_add_u32 v14, v15
    s_mov_b64 exec, -1
    ds_read_b128 v[80:83], v8 offset:7168
    ds_read_b64 v[84:85], v9 offset:8192
    v_exp_f32 v16, v16
    v_exp_f32 v17, v17
    v_exp_f32 v18, v18
    v_exp_f32 v19, v19
    v_cvt_pk_bf16_f32 v70, v44, v45
    v_cvt_pk_bf16_f32 v71, v46, v47
    s_nop 1
    v_mfma_f32_32x32x16_bf16 v[48:63], v[108:111], v[68:71], v[48:63]
    ds_read_b128 v[104:107], v8 offset:5120
    ds_read_b128 v[108:111], v8 offset:6144
    v_exp_f32 v20, v20
    v_exp_f32 v21, v21
    v_exp_f32 v22, v22
    v_exp_f32 v23, v23
    v_cvt_pk_bf16_f32 v64, v16, v17
    v_cvt_pk_bf16_f32 v65, v18, v19
    v_mfma_f32_32x32x16_bf16 v[32:47], v[88:91], v[72:75], 0
    v_exp_f32 v24, v24
    v_exp_f32 v25, v25
    v_exp_f32 v26, v26
    v_exp_f32 v27, v27
    v_cvt_pk_bf16_f32 v66, v20, v21
    v_cvt_pk_bf16_f32 v67, v22, v23
    v_mfma_f32_32x32x8_bf16 v[32:47], v[92:93], v[76:77], v[32:47]
    v_exp_f32 v28, v28
    v_exp_f32 v29, v29
    v_exp_f32 v30, v30
    v_exp_f32 v31, v31
    v_cvt_pk_bf16_f32 v68, v24, v25
    v_cvt_pk_bf16_f32 v69, v26, v27
    v_mfma_f32_32x32x16_bf16 v[48:63], v[96:99], v[64:67], v[48:63]
    s_setprio 0
    s_waitcnt lgkmcnt(0)
    ds_read_b32 v7, v14
    ds_read_b128 v[88:91], v8 offset:10752
    ds_read_b64 v[92:93], v9 offset:11776
    v_exp_f32 v32, v32
    v_exp_f32 v33, v33
    v_exp_f32 v34, v34
    v_exp_f32 v35, v35
    v_cvt_pk_bf16_f32 v70, v28, v29
    v_cvt_pk_bf16_f32 v71, v30, v31
    s_nop 1
    v_mfma_f32_32x32x16_bf16 v[48:63], v[100:103], v[68:71], v[48:63]
    ds_read_b128 v[96:99], v8 offset:8704
    ds_read_b128 v[100:103], v8 offset:9728
    v_exp_f32 v36, v36
    v_exp_f32 v37, v37
    v_exp_f32 v38, v38
    v_exp_f32 v39, v39
    v_cvt_pk_bf16_f32 v64, v32, v33
    v_cvt_pk_bf16_f32 v65, v34, v35
    v_mfma_f32_32x32x16_bf16 v[16:31], v[80:83], v[72:75], 0
    v_exp_f32 v40, v40
    v_exp_f32 v41, v41
    v_exp_f32 v42, v42
    v_exp_f32 v43, v43
    v_cvt_pk_bf16_f32 v66, v36, v37
    v_cvt_pk_bf16_f32 v67, v38, v39
    v_mfma_f32_32x32x8_bf16 v[16:31], v[84:85], v[76:77], v[16:31]
    v_exp_f32 v44, v44
    v_exp_f32 v45, v45
    v_exp_f32 v46, v46
    v_exp_f32 v47, v47
    v_cvt_pk_bf16_f32 v68, v40, v41
    v_cvt_pk_bf16_f32 v69, v42, v43
    v_mfma_f32_32x32x16_bf16 v[48:63], v[104:107], v[64:67], v[48:63]
    s_setprio 3
K2_CHK:
    s_waitcnt lgkmcnt(0)
    v_readfirstlane_b32 s3, v7
    s_cmp_ge_u32 s3, s40
    s_cbranch_scc0 K2_SLOW
    s_add_u32 s40, s40, 8
    ds_read_b128 v[80:83], v10 offset:0
    ds_read_b64 v[84:85], v11 offset:1024
    v_exp_f32 v16, v16
    v_exp_f32 v17, v17
    v_exp_f32 v18, v18
    v_exp_f32 v19, v19
    v_cvt_pk_bf16_f32 v70, v44, v45
    v_cvt_pk_bf16_f32 v71, v46, v47
    s_cmp_eq_u32 s20, 7
    s_cbranch_scc1 K2_SKd
    s_mov_b32 m0, s36
    s_add_u32 s3, s37, 1024
    buffer_load_dwordx4 v3, s[28:31], s37 offen sc1 lds
    s_add_u32 m0, s36, 1024
    s_nop 0
    buffer_load_dwordx4 v3, s[28:31], s3 offen sc1 lds
K2_SKd:
    s_add_u32 s37, s37, 14336
    s_add_u32 s36, s36, 14336
    s_cmp_ge_u32 s36, 57344
    s_cselect_b32 s3, 57344, 0
    s_sub_u32 s36, s36, s3
    v_mfma_f32_32x32x16_bf16 v[48:63], v[108:111], v[68:71], v[48:63]
    ds_read_b128 v[104:107], v8 offset:12288
    ds_read_b128 v[108:111], v8 offset:13312
    v_exp_f32 v20, v20
    v_exp_f32 v21, v21
    v_exp_f32 v22, v22
    v_exp_f32 v23, v23
    v_cvt_pk_bf16_f32 v64, v16, v17
    v_cvt_pk_bf16_f32 v65, v18, v19
    v_mfma_f32_32x32x16_bf16 v[32:47], v[88:91], v[72:75], 0
    v_exp_f32 v24, v24
    v_exp_f32 v25, v25
    v_exp_f32 v26, v26
    v_exp_f32 v27, v27
    v_cvt_pk_bf16_f32 v66, v20, v21
    v_cvt_pk_bf16_f32 v67, v22, v23
    v_mfma_f32_32x32x8_bf16 v[32:47], v[92:93], v[76:77], v[32:47]
    v_exp_f32 v28, v28
    v_exp_f32 v29, v29
    v_exp_f32 v30, v30
    v_exp_f32 v31, v31
    v_cvt_pk_bf16_f32 v68, v24, v25
    v_cvt_pk_bf16_f32 v69, v26, v27
    v_mfma_f32_32x32x16_bf16 v[48:63], v[96:99], v[64:67], v[48:63]
    s_setprio 2
    s_waitcnt lgkmcnt(0)
    s_nop 0
    ds_read_b128 v[88:91], v10 offset:3584
    ds_read_b64 v[92:93], v11 offset:4608
    v_exp_f32 v32, v32
    v_exp_f32 v33, v33
    v_exp_f32 v34, v34
    v_exp_f32 v35, v35
    v_cvt_pk_bf16_f32 v70, v28, v29
    v_cvt_pk_bf16_f32 v71, v30, v31
    s_nop 1
    v_mfma_f32_32x32x16_bf16 v[48:63], v[100:103], v[68:71], v[48:63]
    ds_read_b128 v[96:99], v10 offset:1536
    ds_read_b128 v[100:103], v10 offset:2560
    v_exp_f32 v36, v36
    v_exp_f32 v37, v37
    v_exp_f32 v38, v38
    v_exp_f32 v39, v39
    v_cvt_pk_bf16_f32 v64, v32, v33
    v_cvt_pk_bf16_f32 v65, v34, v35
    v_mfma_f32_32x32x16_bf16 v[16:31], v[80:83], v[72:75], 0
    v_mov_b32 v8, v10
    v_mov_b32 v9, v11
    v_add_u32 v10, s38, v3
    v_add_u32 v11, s38, v4
    s_add_u32 s38, s38, 14336
    s_cmp_ge_u32 s38, 57344
    s_cselect_b32 s3, 57344, 0
    s_sub_u32 s38, s38, s3
    s_add_u32 s39, s39, 1
    v_exp_f32 v40, v40
    v_exp_f32 v41, v41
    v_exp_f32 v42, v42
    v_exp_f32 v43, v43
    v_cvt_pk_bf16_f32 v66, v36, v37
    v_cvt_pk_bf16_f32 v67, v38, v39
    v_mfma_f32_32x32x8_bf16 v[16:31], v[84:85], v[76:77], v[16:31]
    v_exp_f32 v44, v44
    v_exp_f32 v45, v45
    v_exp_f32 v46, v46
    v_exp_f32 v47, v47
    v_cvt_pk_bf16_f32 v68, v40, v41
    v_cvt_pk_bf16_f32 v69, v42, v43
    v_mfma_f32_32x32x16_bf16 v[48:63], v[104:107], v[64:67], v[48:63]
    s_cmp_lt_u32 s39, 16
    s_cbranch_scc1 K2_LOOP
    v_cvt_pk_bf16_f32 v70, v44, v45
    v_cvt_pk_bf16_f32 v71, v46, v47
    s_nop 1
    v_mfma_f32_32x32x16_bf16 v[48:63], v[108:111], v[68:71], v[48:63]
    s_nop 15
    v_max3_f32 v5, |v48|, |v49|, |v50|
    v_max3_f32 v5, v5, |v51|, |v52|
    v_max3_f32 v5, v5, |v53|, |v54|
    v_max3_f32 v5, v5, |v55|, |v56|
    v_max3_f32 v5, v5, |v57|, |v58|
    v_max_f32 v5, v5, |v59|
    s_mov_b32 s3, 0x7b800000
    v_mov_b32 v7, s3
    v_cmp_nlt_f32 s[34:35], v5, v7
    v_mov_b32 v5, v56
    v_mov_b32 v6, v56
    s_nop 1
    v_permlane32_swap_b32 v5, v6
    v_mov_b32 v7, 0x53800000
    s_nop 0
    v_cmp_nlt_f32 vcc, v6, v7
    s_nop 1
    s_or_b64 vcc, vcc, s[34:35]
    s_cbranch_vccnz K2_FALLBACK
K2_NORM:
    v_rcp_f32 v6, v6
    s_nop 0
    v_mul_f32 v6, v6, v13
    v_mul_f32 v48, v48, v6
    v_mul_f32 v49, v49, v6
    v_mul_f32 v50, v50, v6
    v_mul_f32 v51, v51, v6
    v_mul_f32 v52, v52, v6
    v_mul_f32 v53, v53, v6
    v_mul_f32 v54, v54, v6
    v_mul_f32 v55, v55, v6
    v_mul_f32 v56, v56, v6
    v_mul_f32 v57, v57, v6
    v_mul_f32 v58, v58, v6
    v_mul_f32 v59, v59, v6
    v_cvt_pk_bf16_f32 v64, v48, v49
    v_cvt_pk_bf16_f32 v65, v50, v51
    v_cvt_pk_bf16_f32 v66, v52, v53
    v_cvt_pk_bf16_f32 v67, v54, v55
    v_cvt_pk_bf16_f32 v68, v56, v57
    v_cvt_pk_bf16_f32 v69, v58, v59
    s_mul_i32 s3, s21, 40
    s_add_u32 s24, s3, s23
    s_lshl_b32 s24, s24, 10
    s_add_u32 s24, s24, 9437184
    buffer_store_dwordx4 v[64:67], v3, s[28:31], s24 offen sc1
    s_add_u32 s3, s3, 32
    s_lshl_b32 s3, s3, 10
    s_lshl_b32 s25, s23, 8
    s_add_u32 s3, s3, s25
    s_add_u32 s3, s3, 9437184
    s_mov_b32 exec_hi, 0
    buffer_store_dwordx2 v[68:69], v4, s[28:31], s3 offen sc1
    s_lshl_b32 s62, s21, 2
    s_add_u32 s62, s62, s22
    s_lshl_b32 s62, s62, 7
    s_add_u32 s62, s62, 2949120
    v_mov_b32 v6, s77
    v_mov_b32 v7, 0
    s_waitcnt vmcnt(0)
    s_mov_b64 exec, 1
    ds_add_rtn_u32 v5, v14, v15 offset:4
    s_waitcnt lgkmcnt(0)
    v_readfirstlane_b32 s3, v5
    s_cmp_lg_u32 s3, 7
    s_cbranch_scc1 K2_NF
    buffer_store_dword v6, v7, s[28:31], s62 offen sc1
K2_NF:
    s_endpgm
K2_SLOW:
    s_sleep 1
    ds_read_b32 v7, v14
    s_branch K2_CHK
K2_FALLBACK:
    v_cndmask_b32 v76, v76, 0, s[32:33]
    v_mov_b32 v12, 0xff800000
    s_mov_b32 s3, 2621440
K2_FB1:
    buffer_load_dwordx4 v[80:83], v3, s[28:31], s3 offen sc1
    buffer_load_dwordx2 v[84:85], v4, s[28:31], s3 offen offset:1024 sc1
    s_waitcnt vmcnt(0)
    v_mfma_f32_32x32x16_bf16 v[16:31], v[80:83], v[72:75], 0
    v_mfma_f32_32x32x8_bf16 v[16:31], v[84:85], v[76:77], v[16:31]
    s_nop 15
    v_max3_f32 v5, v16, v17, v18
    v_max3_f32 v5, v5, v19, v20
    v_max3_f32 v5, v5, v21, v22
    v_max3_f32 v5, v5, v23, v24
    v_max3_f32 v5, v5, v25, v26
    v_max3_f32 v5, v5, v27, v28
    v_max3_f32 v5, v5, v29, v30
    v_max_f32 v5, v5, v31
    v_max_f32 v12, v12, v5
    s_add_u32 s3, s3, 3584
    s_cmp_lt_u32 s3, 2850816
    s_cbranch_scc1 K2_FB1
    v_mov_b32 v5, v12
    v_mov_b32 v6, v5
    s_nop 1
    v_permlane32_swap_b32 v5, v6
    s_nop 1
    v_max_f32 v5, v5, v6
    v_sub_f32 v5, 0, v5
    v_cvt_pk_bf16_f32 v6, v5, v5
    v_lshlrev_b32 v6, 16, v6
    v_sub_f32 v6, v5, v6
    v_cvt_pk_bf16_f32 v6, v5, v6
    v_cndmask_b32 v76, v76, v6, s[32:33]
    s_nop 1
    v_mov_b32 v48, 0
    v_mov_b32 v49, 0
    v_mov_b32 v50, 0
    v_mov_b32 v51, 0
    v_mov_b32 v52, 0
    v_mov_b32 v53, 0
    v_mov_b32 v54, 0
    v_mov_b32 v55, 0
    v_mov_b32 v56, 0
    v_mov_b32 v57, 0
    v_mov_b32 v58, 0
    v_mov_b32 v59, 0
    v_mov_b32 v60, 0
    v_mov_b32 v61, 0
    v_mov_b32 v62, 0
    v_mov_b32 v63, 0
    s_mov_b32 s3, 2621440
K2_FB2:
    buffer_load_dwordx4 v[80:83], v3, s[28:31], s3 offen sc1
    buffer_load_dwordx2 v[84:85], v4, s[28:31], s3 offen offset:1024 sc1
    buffer_load_dwordx4 v[96:99], v3, s[28:31], s3 offen offset:1536 sc1
    buffer_load_dwordx4 v[100:103], v3, s[28:31], s3 offen offset:2560 sc1
    s_waitcnt vmcnt(0)
    v_mfma_f32_32x32x16_bf16 v[16:31], v[80:83], v[72:75], 0
    v_mfma_f32_32x32x8_bf16 v[16:31], v[84:85], v[76:77], v[16:31]
    s_nop 15
    v_exp_f32 v16, v16
    v_exp_f32 v17, v17
    v_exp_f32 v18, v18
    v_exp_f32 v19, v19
    v_cvt_pk_bf16_f32 v64, v16, v17
    v_cvt_pk_bf16_f32 v65, v18, v19
    v_exp_f32 v20, v20
    v_exp_f32 v21, v21
    v_exp_f32 v22, v22
    v_exp_f32 v23, v23
    v_cvt_pk_bf16_f32 v66, v20, v21
    v_cvt_pk_bf16_f32 v67, v22, v23
    v_exp_f32 v24, v24
    v_exp_f32 v25, v25
    v_exp_f32 v26, v26
    v_exp_f32 v27, v27
    v_cvt_pk_bf16_f32 v68, v24, v25
    v_cvt_pk_bf16_f32 v69, v26, v27
    v_exp_f32 v28, v28
    v_exp_f32 v29, v29
    v_exp_f32 v30, v30
    v_exp_f32 v31, v31
    v_cvt_pk_bf16_f32 v70, v28, v29
    v_cvt_pk_bf16_f32 v71, v30, v31
    s_nop 1
    v_mfma_f32_32x32x16_bf16 v[48:63], v[96:99], v[64:67], v[48:63]
    v_mfma_f32_32x32x16_bf16 v[48:63], v[100:103], v[68:71], v[48:63]
    s_add_u32 s3, s3, 3584
    s_cmp_lt_u32 s3, 2850816
    s_cbranch_scc1 K2_FB2
    s_nop 15
    v_mov_b32 v5, v56
    v_mov_b32 v6, v56
    s_nop 1
    v_permlane32_swap_b32 v5, v6
    s_nop 1
    s_branch K2_NORM
K2_GEMM:
    s_mov_b32 s32, s4
    s_mov_b32 s33, s5
    s_mov_b32 s34, 1966080
    s_mov_b32 s35, 0x00020000
    s_mov_b32 s36, s8
    s_mov_b32 s37, s9
    s_mov_b32 s38, 819200
    s_mov_b32 s39, 0x00020000
    s_mov_b32 s40, s12
    s_mov_b32 s41, s13
    s_mov_b32 s42, 2621440
    s_mov_b32 s43, 0x00020000
    s_mov_b32 s44, s14
    s_mov_b32 s45, s15
    s_mov_b32 s46, 256
    s_mov_b32 s47, 0x00020000
    s_sub_u32 s20, s20, 8
    v_mov_b32 v13, 0
    s_cmp_lg_u32 s20, 0
    s_cbranch_scc1 K2_G0
    s_lshl_b32 s62, s76, 7
    s_add_u32 s62, s62, 3014656
    v_mov_b32 v14, s77
    s_mov_b64 exec, 1
    buffer_store_dword v14, v13, s[28:31], s62 offen sc1
    s_mov_b64 exec, -1
K2_G0:
    s_mul_i32 s3, s20, 3
    v_add_u32 v1, s3, v0
    v_cmp_eq_u32 vcc, 3, v0
    s_nop 1
    v_cndmask_b32 v1, v1, 15, vcc
    s_lshr_b32 s3, s21, 2
    s_lshl_b32 s3, s3, 4
    v_add_u32 v1, s3, v1
    v_lshlrev_b32 v1, 7, v1
    s_mov_b32 s3, 3014656
    s_mov_b32 s63, 0
    s_cmp_eq_u32 s75, 1
    s_cbranch_scc1 K2_G1
    s_barrier
    s_barrier
K2_G1:
    s_barrier
    s_mov_b64 exec, 15
K2_GL:
    buffer_load_dword v2, v1, s[28:31], s3 offen sc1
    s_waitcnt vmcnt(0)
    v_cmp_ne_u32 vcc, s77, v2
    s_nop 1
    s_cbranch_vccz K2_GD
    s_sleep 4
    s_add_u32 s63, s63, 1
    s_cmp_lt_u32 s63, 0x100000
    s_cbranch_scc1 K2_GL
K2_GD:
    s_mov_b64 exec, -1
    s_mul_i32 s58, s20, 25600
    s_add_u32 s58, s58, 57344
    s_mov_b32 s59, 1280
    v_add_u32 v13, 0, v0
    s_mov_b32 s62, 0xCCCCCCCD
    v_mul_hi_u32 v14, v13, s62
    v_lshrrev_b32 v14, 4, v14
    v_mul_u32_u24 v15, 20, v14
    v_sub_u32 v15, v13, v15
    v_lshlrev_b32 v15, 4, v15
    v_mad_u32_u24 v1, v14, s59, v15
    v_bfe_u32 v13, v14, 2, 1
    v_lshrrev_b32 v36, 3, v14
    v_lshl_add_u32 v13, v13, 1, v36
    v_mul_u32_u24 v13, 20, v13
    v_and_b32 v36, 3, v14
    v_add_u32 v13, v13, v36
    v_mad_u32_u24 v6, v13, s59, v15
    v_add_u32 v13, 64, v0
    s_mov_b32 s62, 0xCCCCCCCD
    v_mul_hi_u32 v14, v13, s62
    v_lshrrev_b32 v14, 4, v14
    v_mul_u32_u24 v15, 20, v14
    v_sub_u32 v15, v13, v15
    v_lshlrev_b32 v15, 4, v15
    v_mad_u32_u24 v2, v14, s59, v15
    v_bfe_u32 v13, v14, 2, 1
    v_lshrrev_b32 v36, 3, v14
    v_lshl_add_u32 v13, v13, 1, v36
    v_mul_u32_u24 v13, 20, v13
    v_and_b32 v36, 3, v14
    v_add_u32 v13, v13, v36
    v_mad_u32_u24 v7, v13, s59, v15
    v_add_u32 v13, 128, v0
    s_mov_b32 s62, 0xCCCCCCCD
    v_mul_hi_u32 v14, v13, s62
    v_lshrrev_b32 v14, 4, v14
    v_mul_u32_u24 v15, 20, v14
    v_sub_u32 v15, v13, v15
    v_lshlrev_b32 v15, 4, v15
    v_mad_u32_u24 v3, v14, s59, v15
    v_bfe_u32 v13, v14, 2, 1
    v_lshrrev_b32 v36, 3, v14
    v_lshl_add_u32 v13, v13, 1, v36
    v_mul_u32_u24 v13, 20, v13
    v_and_b32 v36, 3, v14
    v_add_u32 v13, v13, v36
    v_mad_u32_u24 v8, v13, s59, v15
    v_add_u32 v13, 192, v0
    s_mov_b32 s62, 0xCCCCCCCD
    v_mul_hi_u32 v14, v13, s62
    v_lshrrev_b32 v14, 4, v14
    v_mul_u32_u24 v15, 20, v14
    v_sub_u32 v15, v13, v15
    v_lshlrev_b32 v15, 4, v15
    v_mad_u32_u24 v4, v14, s59, v15
    v_bfe_u32 v13, v14, 2, 1
    v_lshrrev_b32 v36, 3, v14
    v_lshl_add_u32 v13, v13, 1, v36
    v_mul_u32_u24 v13, 20, v13
    v_and_b32 v36, 3, v14
    v_add_u32 v13, v13, v36
    v_mad_u32_u24 v9, v13, s59, v15
    v_add_u32 v13, 256, v0
    s_mov_b32 s62, 0xCCCCCCCD
    v_mul_hi_u32 v14, v13, s62
    v_lshrrev_b32 v14, 4, v14
    v_mul_u32_u24 v15, 20, v14
    v_sub_u32 v15, v13, v15
    v_lshlrev_b32 v15, 4, v15
    v_mad_u32_u24 v5, v14, s59, v15
    v_bfe_u32 v13, v14, 2, 1
    v_lshrrev_b32 v36, 3, v14
    v_lshl_add_u32 v13, v13, 1, v36
    v_mul_u32_u24 v13, 20, v13
    v_and_b32 v36, 3, v14
    v_add_u32 v13, v13, v36
    v_mad_u32_u24 v10, v13, s59, v15
    v_bfe_u32 v13, v0, 2, 2
    v_lshrrev_b32 v14, 5, v0
    v_lshl_add_u32 v13, v14, 2, v13
    v_mul_u32_u24 v13, 320, v13
    v_bfe_u32 v14, v0, 4, 1
    v_lshl_add_u32 v13, v14, 5, v13
    v_and_b32 v14, 3, v0
    v_lshl_add_u32 v13, v14, 3, v13
    v_add_u32 v11, s58, v13
    v_lshlrev_b32 v12, 4, v0
    v_and_b32 v13, 31, v0
    v_lshlrev_b32 v13, 2, v13
    s_lshl_b32 s3, s21, 7
    s_add_u32 s3, s3, 2883584
    buffer_load_dword v160, v13, s[28:31], s3 offen sc1
    s_mul_i32 s60, s20, 491520
    s_mul_i32 s3, s22, 320
    s_add_u32 s60, s60, s3
    s_mul_i32 s61, s21, 96
    s_mul_i32 s3, s20, 24
    s_add_u32 s61, s61, s3
    s_lshl_b32 s61, s61, 10
    s_add_u32 s61, s61, 3145728
    s_add_u32 s62, s60, 0
    s_add_u32 m0, s58, 0
    s_nop 0
    buffer_load_dwordx4 v1, s[32:35], s62 offen lds
    s_add_u32 m0, s58, 1024
    s_nop 0
    buffer_load_dwordx4 v2, s[32:35], s62 offen lds
    s_add_u32 m0, s58, 2048
    s_nop 0
    buffer_load_dwordx4 v3, s[32:35], s62 offen lds
    s_add_u32 m0, s58, 3072
    s_nop 0
    buffer_load_dwordx4 v4, s[32:35], s62 offen lds
    s_add_u32 m0, s58, 4096
    s_nop 0
    buffer_load_dwordx4 v5, s[32:35], s62 offen lds
    s_add_u32 s63, s61, 0
    buffer_load_dwordx4 v[40:43], v12, s[28:31], s63 offen sc1
    s_add_u32 s62, s60, 20480
    s_add_u32 m0, s58, 5120
    s_nop 0
    buffer_load_dwordx4 v1, s[32:35], s62 offen lds
    s_add_u32 m0, s58, 6144
    s_nop 0
    buffer_load_dwordx4 v2, s[32:35], s62 offen lds
    s_add_u32 m0, s58, 7168
    s_nop 0
    buffer_load_dwordx4 v3, s[32:35], s62 offen lds
    s_add_u32 m0, s58, 8192
    s_nop 0
    buffer_load_dwordx4 v4, s[32:35], s62 offen lds
    s_add_u32 m0, s58, 9216
    s_nop 0
    buffer_load_dwordx4 v5, s[32:35], s62 offen lds
    s_add_u32 s63, s61, 1024
    buffer_load_dwordx4 v[44:47], v12, s[28:31], s63 offen sc1
    s_add_u32 s62, s60, 40960
    s_add_u32 m0, s58, 10240
    s_nop 0
    buffer_load_dwordx4 v1, s[32:35], s62 offen lds
    s_add_u32 m0, s58, 11264
    s_nop 0
    buffer_load_dwordx4 v2, s[32:35], s62 offen lds
    s_add_u32 m0, s58, 12288
    s_nop 0
    buffer_load_dwordx4 v3, s[32:35], s62 offen lds
    s_add_u32 m0, s58, 13312
    s_nop 0
    buffer_load_dwordx4 v4, s[32:35], s62 offen lds
    s_add_u32 m0, s58, 14336
    s_nop 0
    buffer_load_dwordx4 v5, s[32:35], s62 offen lds
    s_add_u32 s63, s61, 2048
    buffer_load_dwordx4 v[48:51], v12, s[28:31], s63 offen sc1
    s_add_u32 s62, s60, 61440
    s_add_u32 m0, s58, 15360
    s_nop 0
    buffer_load_dwordx4 v1, s[32:35], s62 offen lds
    s_add_u32 m0, s58, 16384
    s_nop 0
    buffer_load_dwordx4 v2, s[32:35], s62 offen lds
    s_add_u32 m0, s58, 17408
    s_nop 0
    buffer_load_dwordx4 v3, s[32:35], s62 offen lds
    s_add_u32 m0, s58, 18432
    s_nop 0
    buffer_load_dwordx4 v4, s[32:35], s62 offen lds
    s_add_u32 m0, s58, 19456
    s_nop 0
    buffer_load_dwordx4 v5, s[32:35], s62 offen lds
    s_add_u32 s63, s61, 3072
    buffer_load_dwordx4 v[52:55], v12, s[28:31], s63 offen sc1
    s_waitcnt vmcnt(18)
    ds_read_b64_tr_b16 v[16:17], v11 offset:0
    ds_read_b64_tr_b16 v[18:19], v11 offset:2560
    ds_read_b64_tr_b16 v[20:21], v11 offset:64
    ds_read_b64_tr_b16 v[22:23], v11 offset:2624
    ds_read_b64_tr_b16 v[24:25], v11 offset:128
    ds_read_b64_tr_b16 v[26:27], v11 offset:2688
    ds_read_b64_tr_b16 v[28:29], v11 offset:192
    ds_read_b64_tr_b16 v[30:31], v11 offset:2752
    ds_read_b64_tr_b16 v[32:33], v11 offset:256
    ds_read_b64_tr_b16 v[34:35], v11 offset:2816
    s_add_u32 s62, s60, 81920
    s_add_u32 m0, s58, 20480
    s_nop 0
    buffer_load_dwordx4 v1, s[32:35], s62 offen lds
    s_add_u32 m0, s58, 21504
    s_nop 0
    buffer_load_dwordx4 v2, s[32:35], s62 offen lds
    s_add_u32 m0, s58, 22528
    s_nop 0
    buffer_load_dwordx4 v3, s[32:35], s62 offen lds
    s_add_u32 m0, s58, 23552
    s_nop 0
    buffer_load_dwordx4 v4, s[32:35], s62 offen lds
    s_add_u32 m0, s58, 24576
    s_nop 0
    buffer_load_dwordx4 v5, s[32:35], s62 offen lds
    s_add_u32 s63, s61, 4096
    buffer_load_dwordx4 v[56:59], v12, s[28:31], s63 offen sc1
    s_waitcnt lgkmcnt(8)
    v_mfma_f32_32x32x16_bf16 v[80:95], v[16:19], v[40:43], 0
    s_waitcnt lgkmcnt(6)
    v_mfma_f32_32x32x16_bf16 v[96:111], v[20:23], v[40:43], 0
    s_waitcnt lgkmcnt(4)
    v_mfma_f32_32x32x16_bf16 v[112:127], v[24:27], v[40:43], 0
    s_waitcnt lgkmcnt(2)
    v_mfma_f32_32x32x16_bf16 v[128:143], v[28:31], v[40:43], 0
    s_waitcnt lgkmcnt(0)
    v_mfma_f32_32x32x16_bf16 v[144:159], v[32:35], v[40:43], 0
    s_waitcnt vmcnt(18)
    ds_read_b64_tr_b16 v[16:17], v11 offset:5120
    ds_read_b64_tr_b16 v[18:19], v11 offset:7680
    ds_read_b64_tr_b16 v[20:21], v11 offset:5184
    ds_read_b64_tr_b16 v[22:23], v11 offset:7744
    ds_read_b64_tr_b16 v[24:25], v11 offset:5248
    ds_read_b64_tr_b16 v[26:27], v11 offset:7808
    ds_read_b64_tr_b16 v[28:29], v11 offset:5312
    ds_read_b64_tr_b16 v[30:31], v11 offset:7872
    ds_read_b64_tr_b16 v[32:33], v11 offset:5376
    ds_read_b64_tr_b16 v[34:35], v11 offset:7936
    s_add_u32 s62, s60, 102400
    s_add_u32 m0, s58, 0
    s_nop 0
    buffer_load_dwordx4 v1, s[32:35], s62 offen lds
    s_add_u32 m0, s58, 1024
    s_nop 0
    buffer_load_dwordx4 v2, s[32:35], s62 offen lds
    s_add_u32 m0, s58, 2048
    s_nop 0
    buffer_load_dwordx4 v3, s[32:35], s62 offen lds
    s_add_u32 m0, s58, 3072
    s_nop 0
    buffer_load_dwordx4 v4, s[32:35], s62 offen lds
    s_add_u32 m0, s58, 4096
    s_nop 0
    buffer_load_dwordx4 v5, s[32:35], s62 offen lds
    s_add_u32 s63, s61, 5120
    buffer_load_dwordx4 v[40:43], v12, s[28:31], s63 offen sc1
    s_waitcnt lgkmcnt(8)
    v_mfma_f32_32x32x16_bf16 v[80:95], v[16:19], v[44:47], v[80:95]
    s_waitcnt lgkmcnt(6)
    v_mfma_f32_32x32x16_bf16 v[96:111], v[20:23], v[44:47], v[96:111]
    s_waitcnt lgkmcnt(4)
    v_mfma_f32_32x32x16_bf16 v[112:127], v[24:27], v[44:47], v[112:127]
    s_waitcnt lgkmcnt(2)
    v_mfma_f32_32x32x16_bf16 v[128:143], v[28:31], v[44:47], v[128:143]
    s_waitcnt lgkmcnt(0)
    v_mfma_f32_32x32x16_bf16 v[144:159], v[32:35], v[44:47], v[144:159]
    s_waitcnt vmcnt(18)
    ds_read_b64_tr_b16 v[16:17], v11 offset:10240
    ds_read_b64_tr_b16 v[18:19], v11 offset:12800
    ds_read_b64_tr_b16 v[20:21], v11 offset:10304
    ds_read_b64_tr_b16 v[22:23], v11 offset:12864
    ds_read_b64_tr_b16 v[24:25], v11 offset:10368
    ds_read_b64_tr_b16 v[26:27], v11 offset:12928
    ds_read_b64_tr_b16 v[28:29], v11 offset:10432
    ds_read_b64_tr_b16 v[30:31], v11 offset:12992
    ds_read_b64_tr_b16 v[32:33], v11 offset:10496
    ds_read_b64_tr_b16 v[34:35], v11 offset:13056
    s_add_u32 s62, s60, 122880
    s_add_u32 m0, s58, 5120
    s_nop 0
    buffer_load_dwordx4 v1, s[32:35], s62 offen lds
    s_add_u32 m0, s58, 6144
    s_nop 0
    buffer_load_dwordx4 v2, s[32:35], s62 offen lds
    s_add_u32 m0, s58, 7168
    s_nop 0
    buffer_load_dwordx4 v3, s[32:35], s62 offen lds
    s_add_u32 m0, s58, 8192
    s_nop 0
    buffer_load_dwordx4 v4, s[32:35], s62 offen lds
    s_add_u32 m0, s58, 9216
    s_nop 0
    buffer_load_dwordx4 v5, s[32:35], s62 offen lds
    s_add_u32 s63, s61, 6144
    buffer_load_dwordx4 v[44:47], v12, s[28:31], s63 offen sc1
    s_waitcnt lgkmcnt(8)
    v_mfma_f32_32x32x16_bf16 v[80:95], v[16:19], v[48:51], v[80:95]
    s_waitcnt lgkmcnt(6)
    v_mfma_f32_32x32x16_bf16 v[96:111], v[20:23], v[48:51], v[96:111]
    s_waitcnt lgkmcnt(4)
    v_mfma_f32_32x32x16_bf16 v[112:127], v[24:27], v[48:51], v[112:127]
    s_waitcnt lgkmcnt(2)
    v_mfma_f32_32x32x16_bf16 v[128:143], v[28:31], v[48:51], v[128:143]
    s_waitcnt lgkmcnt(0)
    v_mfma_f32_32x32x16_bf16 v[144:159], v[32:35], v[48:51], v[144:159]
    s_waitcnt vmcnt(18)
    ds_read_b64_tr_b16 v[16:17], v11 offset:15360
    ds_read_b64_tr_b16 v[18:19], v11 offset:17920
    ds_read_b64_tr_b16 v[20:21], v11 offset:15424
    ds_read_b64_tr_b16 v[22:23], v11 offset:17984
    ds_read_b64_tr_b16 v[24:25], v11 offset:15488
    ds_read_b64_tr_b16 v[26:27], v11 offset:18048
    ds_read_b64_tr_b16 v[28:29], v11 offset:15552
    ds_read_b64_tr_b16 v[30:31], v11 offset:18112
    ds_read_b64_tr_b16 v[32:33], v11 offset:15616
    ds_read_b64_tr_b16 v[34:35], v11 offset:18176
    s_add_u32 s62, s60, 143360
    s_add_u32 m0, s58, 10240
    s_nop 0
    buffer_load_dwordx4 v1, s[32:35], s62 offen lds
    s_add_u32 m0, s58, 11264
    s_nop 0
    buffer_load_dwordx4 v2, s[32:35], s62 offen lds
    s_add_u32 m0, s58, 12288
    s_nop 0
    buffer_load_dwordx4 v3, s[32:35], s62 offen lds
    s_add_u32 m0, s58, 13312
    s_nop 0
    buffer_load_dwordx4 v4, s[32:35], s62 offen lds
    s_add_u32 m0, s58, 14336
    s_nop 0
    buffer_load_dwordx4 v5, s[32:35], s62 offen lds
    s_add_u32 s63, s61, 7168
    buffer_load_dwordx4 v[48:51], v12, s[28:31], s63 offen sc1
    s_waitcnt lgkmcnt(8)
    v_mfma_f32_32x32x16_bf16 v[80:95], v[16:19], v[52:55], v[80:95]
    s_waitcnt lgkmcnt(6)
    v_mfma_f32_32x32x16_bf16 v[96:111], v[20:23], v[52:55], v[96:111]
    s_waitcnt lgkmcnt(4)
    v_mfma_f32_32x32x16_bf16 v[112:127], v[24:27], v[52:55], v[112:127]
    s_waitcnt lgkmcnt(2)
    v_mfma_f32_32x32x16_bf16 v[128:143], v[28:31], v[52:55], v[128:143]
    s_waitcnt lgkmcnt(0)
    v_mfma_f32_32x32x16_bf16 v[144:159], v[32:35], v[52:55], v[144:159]
    s_waitcnt vmcnt(18)
    ds_read_b64_tr_b16 v[16:17], v11 offset:20480
    ds_read_b64_tr_b16 v[18:19], v11 offset:23040
    ds_read_b64_tr_b16 v[20:21], v11 offset:20544
    ds_read_b64_tr_b16 v[22:23], v11 offset:23104
    ds_read_b64_tr_b16 v[24:25], v11 offset:20608
    ds_read_b64_tr_b16 v[26:27], v11 offset:23168
    ds_read_b64_tr_b16 v[28:29], v11 offset:20672
    ds_read_b64_tr_b16 v[30:31], v11 offset:23232
    ds_read_b64_tr_b16 v[32:33], v11 offset:20736
    ds_read_b64_tr_b16 v[34:35], v11 offset:23296
    s_add_u32 s62, s60, 163840
    s_add_u32 m0, s58, 15360
    s_nop 0
    buffer_load_dwordx4 v1, s[32:35], s62 offen lds
    s_add_u32 m0, s58, 16384
    s_nop 0
    buffer_load_dwordx4 v2, s[32:35], s62 offen lds
    s_add_u32 m0, s58, 17408
    s_nop 0
    buffer_load_dwordx4 v3, s[32:35], s62 offen lds
    s_add_u32 m0, s58, 18432
    s_nop 0
    buffer_load_dwordx4 v4, s[32:35], s62 offen lds
    s_add_u32 m0, s58, 19456
    s_nop 0
    buffer_load_dwordx4 v5, s[32:35], s62 offen lds
    s_add_u32 s63, s61, 8192
    buffer_load_dwordx4 v[52:55], v12, s[28:31], s63 offen sc1
    s_waitcnt lgkmcnt(8)
    v_mfma_f32_32x32x16_bf16 v[80:95], v[16:19], v[56:59], v[80:95]
    s_waitcnt lgkmcnt(6)
    v_mfma_f32_32x32x16_bf16 v[96:111], v[20:23], v[56:59], v[96:111]
    s_waitcnt lgkmcnt(4)
    v_mfma_f32_32x32x16_bf16 v[112:127], v[24:27], v[56:59], v[112:127]
    s_waitcnt lgkmcnt(2)
    v_mfma_f32_32x32x16_bf16 v[128:143], v[28:31], v[56:59], v[128:143]
    s_waitcnt lgkmcnt(0)
    v_mfma_f32_32x32x16_bf16 v[144:159], v[32:35], v[56:59], v[144:159]
    s_waitcnt vmcnt(18)
    ds_read_b64_tr_b16 v[16:17], v11 offset:0
    ds_read_b64_tr_b16 v[18:19], v11 offset:2560
    ds_read_b64_tr_b16 v[20:21], v11 offset:64
    ds_read_b64_tr_b16 v[22:23], v11 offset:2624
    ds_read_b64_tr_b16 v[24:25], v11 offset:128
    ds_read_b64_tr_b16 v[26:27], v11 offset:2688
    ds_read_b64_tr_b16 v[28:29], v11 offset:192
    ds_read_b64_tr_b16 v[30:31], v11 offset:2752
    ds_read_b64_tr_b16 v[32:33], v11 offset:256
    ds_read_b64_tr_b16 v[34:35], v11 offset:2816
    s_add_u32 s62, s60, 184320
    s_add_u32 m0, s58, 20480
    s_nop 0
    buffer_load_dwordx4 v1, s[32:35], s62 offen lds
    s_add_u32 m0, s58, 21504
    s_nop 0
    buffer_load_dwordx4 v2, s[32:35], s62 offen lds
    s_add_u32 m0, s58, 22528
    s_nop 0
    buffer_load_dwordx4 v3, s[32:35], s62 offen lds
    s_add_u32 m0, s58, 23552
    s_nop 0
    buffer_load_dwordx4 v4, s[32:35], s62 offen lds
    s_add_u32 m0, s58, 24576
    s_nop 0
    buffer_load_dwordx4 v5, s[32:35], s62 offen lds
    s_add_u32 s63, s61, 9216
    buffer_load_dwordx4 v[56:59], v12, s[28:31], s63 offen sc1
    s_waitcnt lgkmcnt(8)
    v_mfma_f32_32x32x16_bf16 v[80:95], v[16:19], v[40:43], v[80:95]
    s_waitcnt lgkmcnt(6)
    v_mfma_f32_32x32x16_bf16 v[96:111], v[20:23], v[40:43], v[96:111]
    s_waitcnt lgkmcnt(4)
    v_mfma_f32_32x32x16_bf16 v[112:127], v[24:27], v[40:43], v[112:127]
    s_waitcnt lgkmcnt(2)
    v_mfma_f32_32x32x16_bf16 v[128:143], v[28:31], v[40:43], v[128:143]
    s_waitcnt lgkmcnt(0)
    v_mfma_f32_32x32x16_bf16 v[144:159], v[32:35], v[40:43], v[144:159]
    s_waitcnt vmcnt(18)
    ds_read_b64_tr_b16 v[16:17], v11 offset:5120
    ds_read_b64_tr_b16 v[18:19], v11 offset:7680
    ds_read_b64_tr_b16 v[20:21], v11 offset:5184
    ds_read_b64_tr_b16 v[22:23], v11 offset:7744
    ds_read_b64_tr_b16 v[24:25], v11 offset:5248
    ds_read_b64_tr_b16 v[26:27], v11 offset:7808
    ds_read_b64_tr_b16 v[28:29], v11 offset:5312
    ds_read_b64_tr_b16 v[30:31], v11 offset:7872
    ds_read_b64_tr_b16 v[32:33], v11 offset:5376
    ds_read_b64_tr_b16 v[34:35], v11 offset:7936
    s_add_u32 s62, s60, 204800
    s_add_u32 m0, s58, 0
    s_nop 0
    buffer_load_dwordx4 v1, s[32:35], s62 offen lds
    s_add_u32 m0, s58, 1024
    s_nop 0
    buffer_load_dwordx4 v2, s[32:35], s62 offen lds
    s_add_u32 m0, s58, 2048
    s_nop 0
    buffer_load_dwordx4 v3, s[32:35], s62 offen lds
    s_add_u32 m0, s58, 3072
    s_nop 0
    buffer_load_dwordx4 v4, s[32:35], s62 offen lds
    s_add_u32 m0, s58, 4096
    s_nop 0
    buffer_load_dwordx4 v5, s[32:35], s62 offen lds
    s_add_u32 s63, s61, 10240
    buffer_load_dwordx4 v[40:43], v12, s[28:31], s63 offen sc1
    s_waitcnt lgkmcnt(8)
    v_mfma_f32_32x32x16_bf16 v[80:95], v[16:19], v[44:47], v[80:95]
    s_waitcnt lgkmcnt(6)
    v_mfma_f32_32x32x16_bf16 v[96:111], v[20:23], v[44:47], v[96:111]
    s_waitcnt lgkmcnt(4)
    v_mfma_f32_32x32x16_bf16 v[112:127], v[24:27], v[44:47], v[112:127]
    s_waitcnt lgkmcnt(2)
    v_mfma_f32_32x32x16_bf16 v[128:143], v[28:31], v[44:47], v[128:143]
    s_waitcnt lgkmcnt(0)
    v_mfma_f32_32x32x16_bf16 v[144:159], v[32:35], v[44:47], v[144:159]
    s_waitcnt vmcnt(18)
    ds_read_b64_tr_b16 v[16:17], v11 offset:10240
    ds_read_b64_tr_b16 v[18:19], v11 offset:12800
    ds_read_b64_tr_b16 v[20:21], v11 offset:10304
    ds_read_b64_tr_b16 v[22:23], v11 offset:12864
    ds_read_b64_tr_b16 v[24:25], v11 offset:10368
    ds_read_b64_tr_b16 v[26:27], v11 offset:12928
    ds_read_b64_tr_b16 v[28:29], v11 offset:10432
    ds_read_b64_tr_b16 v[30:31], v11 offset:12992
    ds_read_b64_tr_b16 v[32:33], v11 offset:10496
    ds_read_b64_tr_b16 v[34:35], v11 offset:13056
    s_add_u32 s62, s60, 225280
    s_add_u32 m0, s58, 5120
    s_nop 0
    buffer_load_dwordx4 v1, s[32:35], s62 offen lds
    s_add_u32 m0, s58, 6144
    s_nop 0
    buffer_load_dwordx4 v2, s[32:35], s62 offen lds
    s_add_u32 m0, s58, 7168
    s_nop 0
    buffer_load_dwordx4 v3, s[32:35], s62 offen lds
    s_add_u32 m0, s58, 8192
    s_nop 0
    buffer_load_dwordx4 v4, s[32:35], s62 offen lds
    s_add_u32 m0, s58, 9216
    s_nop 0
    buffer_load_dwordx4 v5, s[32:35], s62 offen lds
    s_add_u32 s63, s61, 11264
    buffer_load_dwordx4 v[44:47], v12, s[28:31], s63 offen sc1
    s_waitcnt lgkmcnt(8)
    v_mfma_f32_32x32x16_bf16 v[80:95], v[16:19], v[48:51], v[80:95]
    s_waitcnt lgkmcnt(6)
    v_mfma_f32_32x32x16_bf16 v[96:111], v[20:23], v[48:51], v[96:111]
    s_waitcnt lgkmcnt(4)
    v_mfma_f32_32x32x16_bf16 v[112:127], v[24:27], v[48:51], v[112:127]
    s_waitcnt lgkmcnt(2)
    v_mfma_f32_32x32x16_bf16 v[128:143], v[28:31], v[48:51], v[128:143]
    s_waitcnt lgkmcnt(0)
    v_mfma_f32_32x32x16_bf16 v[144:159], v[32:35], v[48:51], v[144:159]
    s_waitcnt vmcnt(18)
    ds_read_b64_tr_b16 v[16:17], v11 offset:15360
    ds_read_b64_tr_b16 v[18:19], v11 offset:17920
    ds_read_b64_tr_b16 v[20:21], v11 offset:15424
    ds_read_b64_tr_b16 v[22:23], v11 offset:17984
    ds_read_b64_tr_b16 v[24:25], v11 offset:15488
    ds_read_b64_tr_b16 v[26:27], v11 offset:18048
    ds_read_b64_tr_b16 v[28:29], v11 offset:15552
    ds_read_b64_tr_b16 v[30:31], v11 offset:18112
    ds_read_b64_tr_b16 v[32:33], v11 offset:15616
    ds_read_b64_tr_b16 v[34:35], v11 offset:18176
    s_add_u32 s62, s60, 245760
    s_add_u32 m0, s58, 10240
    s_nop 0
    buffer_load_dwordx4 v1, s[32:35], s62 offen lds
    s_add_u32 m0, s58, 11264
    s_nop 0
    buffer_load_dwordx4 v2, s[32:35], s62 offen lds
    s_add_u32 m0, s58, 12288
    s_nop 0
    buffer_load_dwordx4 v3, s[32:35], s62 offen lds
    s_add_u32 m0, s58, 13312
    s_nop 0
    buffer_load_dwordx4 v4, s[32:35], s62 offen lds
    s_add_u32 m0, s58, 14336
    s_nop 0
    buffer_load_dwordx4 v5, s[32:35], s62 offen lds
    s_add_u32 s63, s61, 12288
    buffer_load_dwordx4 v[48:51], v12, s[28:31], s63 offen sc1
    s_waitcnt lgkmcnt(8)
    v_mfma_f32_32x32x16_bf16 v[80:95], v[16:19], v[52:55], v[80:95]
    s_waitcnt lgkmcnt(6)
    v_mfma_f32_32x32x16_bf16 v[96:111], v[20:23], v[52:55], v[96:111]
    s_waitcnt lgkmcnt(4)
    v_mfma_f32_32x32x16_bf16 v[112:127], v[24:27], v[52:55], v[112:127]
    s_waitcnt lgkmcnt(2)
    v_mfma_f32_32x32x16_bf16 v[128:143], v[28:31], v[52:55], v[128:143]
    s_waitcnt lgkmcnt(0)
    v_mfma_f32_32x32x16_bf16 v[144:159], v[32:35], v[52:55], v[144:159]
    s_waitcnt vmcnt(18)
    ds_read_b64_tr_b16 v[16:17], v11 offset:20480
    ds_read_b64_tr_b16 v[18:19], v11 offset:23040
    ds_read_b64_tr_b16 v[20:21], v11 offset:20544
    ds_read_b64_tr_b16 v[22:23], v11 offset:23104
    ds_read_b64_tr_b16 v[24:25], v11 offset:20608
    ds_read_b64_tr_b16 v[26:27], v11 offset:23168
    ds_read_b64_tr_b16 v[28:29], v11 offset:20672
    ds_read_b64_tr_b16 v[30:31], v11 offset:23232
    ds_read_b64_tr_b16 v[32:33], v11 offset:20736
    ds_read_b64_tr_b16 v[34:35], v11 offset:23296
    s_add_u32 s62, s60, 266240
    s_add_u32 m0, s58, 15360
    s_nop 0
    buffer_load_dwordx4 v1, s[32:35], s62 offen lds
    s_add_u32 m0, s58, 16384
    s_nop 0
    buffer_load_dwordx4 v2, s[32:35], s62 offen lds
    s_add_u32 m0, s58, 17408
    s_nop 0
    buffer_load_dwordx4 v3, s[32:35], s62 offen lds
    s_add_u32 m0, s58, 18432
    s_nop 0
    buffer_load_dwordx4 v4, s[32:35], s62 offen lds
    s_add_u32 m0, s58, 19456
    s_nop 0
    buffer_load_dwordx4 v5, s[32:35], s62 offen lds
    s_add_u32 s63, s61, 13312
    buffer_load_dwordx4 v[52:55], v12, s[28:31], s63 offen sc1
    s_waitcnt lgkmcnt(8)
    v_mfma_f32_32x32x16_bf16 v[80:95], v[16:19], v[56:59], v[80:95]
    s_waitcnt lgkmcnt(6)
    v_mfma_f32_32x32x16_bf16 v[96:111], v[20:23], v[56:59], v[96:111]
    s_waitcnt lgkmcnt(4)
    v_mfma_f32_32x32x16_bf16 v[112:127], v[24:27], v[56:59], v[112:127]
    s_waitcnt lgkmcnt(2)
    v_mfma_f32_32x32x16_bf16 v[128:143], v[28:31], v[56:59], v[128:143]
    s_waitcnt lgkmcnt(0)
    v_mfma_f32_32x32x16_bf16 v[144:159], v[32:35], v[56:59], v[144:159]
    s_waitcnt vmcnt(18)
    ds_read_b64_tr_b16 v[16:17], v11 offset:0
    ds_read_b64_tr_b16 v[18:19], v11 offset:2560
    ds_read_b64_tr_b16 v[20:21], v11 offset:64
    ds_read_b64_tr_b16 v[22:23], v11 offset:2624
    ds_read_b64_tr_b16 v[24:25], v11 offset:128
    ds_read_b64_tr_b16 v[26:27], v11 offset:2688
    ds_read_b64_tr_b16 v[28:29], v11 offset:192
    ds_read_b64_tr_b16 v[30:31], v11 offset:2752
    ds_read_b64_tr_b16 v[32:33], v11 offset:256
    ds_read_b64_tr_b16 v[34:35], v11 offset:2816
    s_add_u32 s62, s60, 286720
    s_add_u32 m0, s58, 20480
    s_nop 0
    buffer_load_dwordx4 v1, s[32:35], s62 offen lds
    s_add_u32 m0, s58, 21504
    s_nop 0
    buffer_load_dwordx4 v2, s[32:35], s62 offen lds
    s_add_u32 m0, s58, 22528
    s_nop 0
    buffer_load_dwordx4 v3, s[32:35], s62 offen lds
    s_add_u32 m0, s58, 23552
    s_nop 0
    buffer_load_dwordx4 v4, s[32:35], s62 offen lds
    s_add_u32 m0, s58, 24576
    s_nop 0
    buffer_load_dwordx4 v5, s[32:35], s62 offen lds
    s_add_u32 s63, s61, 14336
    buffer_load_dwordx4 v[56:59], v12, s[28:31], s63 offen sc1
    s_waitcnt lgkmcnt(8)
    v_mfma_f32_32x32x16_bf16 v[80:95], v[16:19], v[40:43], v[80:95]
    s_waitcnt lgkmcnt(6)
    v_mfma_f32_32x32x16_bf16 v[96:111], v[20:23], v[40:43], v[96:111]
    s_waitcnt lgkmcnt(4)
    v_mfma_f32_32x32x16_bf16 v[112:127], v[24:27], v[40:43], v[112:127]
    s_waitcnt lgkmcnt(2)
    v_mfma_f32_32x32x16_bf16 v[128:143], v[28:31], v[40:43], v[128:143]
    s_waitcnt lgkmcnt(0)
    v_mfma_f32_32x32x16_bf16 v[144:159], v[32:35], v[40:43], v[144:159]
    s_waitcnt vmcnt(18)
    ds_read_b64_tr_b16 v[16:17], v11 offset:5120
    ds_read_b64_tr_b16 v[18:19], v11 offset:7680
    ds_read_b64_tr_b16 v[20:21], v11 offset:5184
    ds_read_b64_tr_b16 v[22:23], v11 offset:7744
    ds_read_b64_tr_b16 v[24:25], v11 offset:5248
    ds_read_b64_tr_b16 v[26:27], v11 offset:7808
    ds_read_b64_tr_b16 v[28:29], v11 offset:5312
    ds_read_b64_tr_b16 v[30:31], v11 offset:7872
    ds_read_b64_tr_b16 v[32:33], v11 offset:5376
    ds_read_b64_tr_b16 v[34:35], v11 offset:7936
    s_add_u32 s62, s60, 307200
    s_add_u32 m0, s58, 0
    s_nop 0
    buffer_load_dwordx4 v1, s[32:35], s62 offen lds
    s_add_u32 m0, s58, 1024
    s_nop 0
    buffer_load_dwordx4 v2, s[32:35], s62 offen lds
    s_add_u32 m0, s58, 2048
    s_nop 0
    buffer_load_dwordx4 v3, s[32:35], s62 offen lds
    s_add_u32 m0, s58, 3072
    s_nop 0
    buffer_load_dwordx4 v4, s[32:35], s62 offen lds
    s_add_u32 m0, s58, 4096
    s_nop 0
    buffer_load_dwordx4 v5, s[32:35], s62 offen lds
    s_add_u32 s63, s61, 15360
    buffer_load_dwordx4 v[40:43], v12, s[28:31], s63 offen sc1
    s_waitcnt lgkmcnt(8)
    v_mfma_f32_32x32x16_bf16 v[80:95], v[16:19], v[44:47], v[80:95]
    s_waitcnt lgkmcnt(6)
    v_mfma_f32_32x32x16_bf16 v[96:111], v[20:23], v[44:47], v[96:111]
    s_waitcnt lgkmcnt(4)
    v_mfma_f32_32x32x16_bf16 v[112:127], v[24:27], v[44:47], v[112:127]
    s_waitcnt lgkmcnt(2)
    v_mfma_f32_32x32x16_bf16 v[128:143], v[28:31], v[44:47], v[128:143]
    s_waitcnt lgkmcnt(0)
    v_mfma_f32_32x32x16_bf16 v[144:159], v[32:35], v[44:47], v[144:159]
    s_waitcnt vmcnt(18)
    ds_read_b64_tr_b16 v[16:17], v11 offset:10240
    ds_read_b64_tr_b16 v[18:19], v11 offset:12800
    ds_read_b64_tr_b16 v[20:21], v11 offset:10304
    ds_read_b64_tr_b16 v[22:23], v11 offset:12864
    ds_read_b64_tr_b16 v[24:25], v11 offset:10368
    ds_read_b64_tr_b16 v[26:27], v11 offset:12928
    ds_read_b64_tr_b16 v[28:29], v11 offset:10432
    ds_read_b64_tr_b16 v[30:31], v11 offset:12992
    ds_read_b64_tr_b16 v[32:33], v11 offset:10496
    ds_read_b64_tr_b16 v[34:35], v11 offset:13056
    s_add_u32 s62, s60, 327680
    s_add_u32 m0, s58, 5120
    s_nop 0
    buffer_load_dwordx4 v1, s[32:35], s62 offen lds
    s_add_u32 m0, s58, 6144
    s_nop 0
    buffer_load_dwordx4 v2, s[32:35], s62 offen lds
    s_add_u32 m0, s58, 7168
    s_nop 0
    buffer_load_dwordx4 v3, s[32:35], s62 offen lds
    s_add_u32 m0, s58, 8192
    s_nop 0
    buffer_load_dwordx4 v4, s[32:35], s62 offen lds
    s_add_u32 m0, s58, 9216
    s_nop 0
    buffer_load_dwordx4 v5, s[32:35], s62 offen lds
    s_add_u32 s63, s61, 16384
    buffer_load_dwordx4 v[44:47], v12, s[28:31], s63 offen sc1
    s_waitcnt lgkmcnt(8)
    v_mfma_f32_32x32x16_bf16 v[80:95], v[16:19], v[48:51], v[80:95]
    s_waitcnt lgkmcnt(6)
    v_mfma_f32_32x32x16_bf16 v[96:111], v[20:23], v[48:51], v[96:111]
    s_waitcnt lgkmcnt(4)
    v_mfma_f32_32x32x16_bf16 v[112:127], v[24:27], v[48:51], v[112:127]
    s_waitcnt lgkmcnt(2)
    v_mfma_f32_32x32x16_bf16 v[128:143], v[28:31], v[48:51], v[128:143]
    s_waitcnt lgkmcnt(0)
    v_mfma_f32_32x32x16_bf16 v[144:159], v[32:35], v[48:51], v[144:159]
    s_waitcnt vmcnt(18)
    ds_read_b64_tr_b16 v[16:17], v11 offset:15360
    ds_read_b64_tr_b16 v[18:19], v11 offset:17920
    ds_read_b64_tr_b16 v[20:21], v11 offset:15424
    ds_read_b64_tr_b16 v[22:23], v11 offset:17984
    ds_read_b64_tr_b16 v[24:25], v11 offset:15488
    ds_read_b64_tr_b16 v[26:27], v11 offset:18048
    ds_read_b64_tr_b16 v[28:29], v11 offset:15552
    ds_read_b64_tr_b16 v[30:31], v11 offset:18112
    ds_read_b64_tr_b16 v[32:33], v11 offset:15616
    ds_read_b64_tr_b16 v[34:35], v11 offset:18176
    s_add_u32 s62, s60, 348160
    s_add_u32 m0, s58, 10240
    s_nop 0
    buffer_load_dwordx4 v1, s[32:35], s62 offen lds
    s_add_u32 m0, s58, 11264
    s_nop 0
    buffer_load_dwordx4 v2, s[32:35], s62 offen lds
    s_add_u32 m0, s58, 12288
    s_nop 0
    buffer_load_dwordx4 v3, s[32:35], s62 offen lds
    s_add_u32 m0, s58, 13312
    s_nop 0
    buffer_load_dwordx4 v4, s[32:35], s62 offen lds
    s_add_u32 m0, s58, 14336
    s_nop 0
    buffer_load_dwordx4 v5, s[32:35], s62 offen lds
    s_add_u32 s63, s61, 17408
    buffer_load_dwordx4 v[48:51], v12, s[28:31], s63 offen sc1
    s_waitcnt lgkmcnt(8)
    v_mfma_f32_32x32x16_bf16 v[80:95], v[16:19], v[52:55], v[80:95]
    s_waitcnt lgkmcnt(6)
    v_mfma_f32_32x32x16_bf16 v[96:111], v[20:23], v[52:55], v[96:111]
    s_waitcnt lgkmcnt(4)
    v_mfma_f32_32x32x16_bf16 v[112:127], v[24:27], v[52:55], v[112:127]
    s_waitcnt lgkmcnt(2)
    v_mfma_f32_32x32x16_bf16 v[128:143], v[28:31], v[52:55], v[128:143]
    s_waitcnt lgkmcnt(0)
    v_mfma_f32_32x32x16_bf16 v[144:159], v[32:35], v[52:55], v[144:159]
    s_waitcnt vmcnt(18)
    ds_read_b64_tr_b16 v[16:17], v11 offset:20480
    ds_read_b64_tr_b16 v[18:19], v11 offset:23040
    ds_read_b64_tr_b16 v[20:21], v11 offset:20544
    ds_read_b64_tr_b16 v[22:23], v11 offset:23104
    ds_read_b64_tr_b16 v[24:25], v11 offset:20608
    ds_read_b64_tr_b16 v[26:27], v11 offset:23168
    ds_read_b64_tr_b16 v[28:29], v11 offset:20672
    ds_read_b64_tr_b16 v[30:31], v11 offset:23232
    ds_read_b64_tr_b16 v[32:33], v11 offset:20736
    ds_read_b64_tr_b16 v[34:35], v11 offset:23296
    s_add_u32 s62, s60, 368640
    s_add_u32 m0, s58, 15360
    s_nop 0
    buffer_load_dwordx4 v1, s[32:35], s62 offen lds
    s_add_u32 m0, s58, 16384
    s_nop 0
    buffer_load_dwordx4 v2, s[32:35], s62 offen lds
    s_add_u32 m0, s58, 17408
    s_nop 0
    buffer_load_dwordx4 v3, s[32:35], s62 offen lds
    s_add_u32 m0, s58, 18432
    s_nop 0
    buffer_load_dwordx4 v4, s[32:35], s62 offen lds
    s_add_u32 m0, s58, 19456
    s_nop 0
    buffer_load_dwordx4 v5, s[32:35], s62 offen lds
    s_add_u32 s63, s61, 18432
    buffer_load_dwordx4 v[52:55], v12, s[28:31], s63 offen sc1
    s_waitcnt lgkmcnt(8)
    v_mfma_f32_32x32x16_bf16 v[80:95], v[16:19], v[56:59], v[80:95]
    s_waitcnt lgkmcnt(6)
    v_mfma_f32_32x32x16_bf16 v[96:111], v[20:23], v[56:59], v[96:111]
    s_waitcnt lgkmcnt(4)
    v_mfma_f32_32x32x16_bf16 v[112:127], v[24:27], v[56:59], v[112:127]
    s_waitcnt lgkmcnt(2)
    v_mfma_f32_32x32x16_bf16 v[128:143], v[28:31], v[56:59], v[128:143]
    s_waitcnt lgkmcnt(0)
    v_mfma_f32_32x32x16_bf16 v[144:159], v[32:35], v[56:59], v[144:159]
    s_waitcnt vmcnt(18)
    ds_read_b64_tr_b16 v[16:17], v11 offset:0
    ds_read_b64_tr_b16 v[18:19], v11 offset:2560
    ds_read_b64_tr_b16 v[20:21], v11 offset:64
    ds_read_b64_tr_b16 v[22:23], v11 offset:2624
    ds_read_b64_tr_b16 v[24:25], v11 offset:128
    ds_read_b64_tr_b16 v[26:27], v11 offset:2688
    ds_read_b64_tr_b16 v[28:29], v11 offset:192
    ds_read_b64_tr_b16 v[30:31], v11 offset:2752
    ds_read_b64_tr_b16 v[32:33], v11 offset:256
    ds_read_b64_tr_b16 v[34:35], v11 offset:2816
    s_add_u32 s62, s60, 389120
    s_add_u32 m0, s58, 20480
    s_nop 0
    buffer_load_dwordx4 v1, s[32:35], s62 offen lds
    s_add_u32 m0, s58, 21504
    s_nop 0
    buffer_load_dwordx4 v2, s[32:35], s62 offen lds
    s_add_u32 m0, s58, 22528
    s_nop 0
    buffer_load_dwordx4 v3, s[32:35], s62 offen lds
    s_add_u32 m0, s58, 23552
    s_nop 0
    buffer_load_dwordx4 v4, s[32:35], s62 offen lds
    s_add_u32 m0, s58, 24576
    s_nop 0
    buffer_load_dwordx4 v5, s[32:35], s62 offen lds
    s_add_u32 s63, s61, 19456
    buffer_load_dwordx4 v[56:59], v12, s[28:31], s63 offen sc1
    s_waitcnt lgkmcnt(8)
    v_mfma_f32_32x32x16_bf16 v[80:95], v[16:19], v[40:43], v[80:95]
    s_waitcnt lgkmcnt(6)
    v_mfma_f32_32x32x16_bf16 v[96:111], v[20:23], v[40:43], v[96:111]
    s_waitcnt lgkmcnt(4)
    v_mfma_f32_32x32x16_bf16 v[112:127], v[24:27], v[40:43], v[112:127]
    s_waitcnt lgkmcnt(2)
    v_mfma_f32_32x32x16_bf16 v[128:143], v[28:31], v[40:43], v[128:143]
    s_waitcnt lgkmcnt(0)
    v_mfma_f32_32x32x16_bf16 v[144:159], v[32:35], v[40:43], v[144:159]
    s_waitcnt vmcnt(18)
    ds_read_b64_tr_b16 v[16:17], v11 offset:5120
    ds_read_b64_tr_b16 v[18:19], v11 offset:7680
    ds_read_b64_tr_b16 v[20:21], v11 offset:5184
    ds_read_b64_tr_b16 v[22:23], v11 offset:7744
    ds_read_b64_tr_b16 v[24:25], v11 offset:5248
    ds_read_b64_tr_b16 v[26:27], v11 offset:7808
    ds_read_b64_tr_b16 v[28:29], v11 offset:5312
    ds_read_b64_tr_b16 v[30:31], v11 offset:7872
    ds_read_b64_tr_b16 v[32:33], v11 offset:5376
    ds_read_b64_tr_b16 v[34:35], v11 offset:7936
    s_add_u32 s62, s60, 409600
    s_add_u32 m0, s58, 0
    s_nop 0
    buffer_load_dwordx4 v1, s[32:35], s62 offen lds
    s_add_u32 m0, s58, 1024
    s_nop 0
    buffer_load_dwordx4 v2, s[32:35], s62 offen lds
    s_add_u32 m0, s58, 2048
    s_nop 0
    buffer_load_dwordx4 v3, s[32:35], s62 offen lds
    s_add_u32 m0, s58, 3072
    s_nop 0
    buffer_load_dwordx4 v4, s[32:35], s62 offen lds
    s_add_u32 m0, s58, 4096
    s_nop 0
    buffer_load_dwordx4 v5, s[32:35], s62 offen lds
    s_add_u32 s63, s61, 20480
    buffer_load_dwordx4 v[40:43], v12, s[28:31], s63 offen sc1
    s_waitcnt lgkmcnt(8)
    v_mfma_f32_32x32x16_bf16 v[80:95], v[16:19], v[44:47], v[80:95]
    s_waitcnt lgkmcnt(6)
    v_mfma_f32_32x32x16_bf16 v[96:111], v[20:23], v[44:47], v[96:111]
    s_waitcnt lgkmcnt(4)
    v_mfma_f32_32x32x16_bf16 v[112:127], v[24:27], v[44:47], v[112:127]
    s_waitcnt lgkmcnt(2)
    v_mfma_f32_32x32x16_bf16 v[128:143], v[28:31], v[44:47], v[128:143]
    s_waitcnt lgkmcnt(0)
    v_mfma_f32_32x32x16_bf16 v[144:159], v[32:35], v[44:47], v[144:159]
    s_waitcnt vmcnt(18)
    ds_read_b64_tr_b16 v[16:17], v11 offset:10240
    ds_read_b64_tr_b16 v[18:19], v11 offset:12800
    ds_read_b64_tr_b16 v[20:21], v11 offset:10304
    ds_read_b64_tr_b16 v[22:23], v11 offset:12864
    ds_read_b64_tr_b16 v[24:25], v11 offset:10368
    ds_read_b64_tr_b16 v[26:27], v11 offset:12928
    ds_read_b64_tr_b16 v[28:29], v11 offset:10432
    ds_read_b64_tr_b16 v[30:31], v11 offset:12992
    ds_read_b64_tr_b16 v[32:33], v11 offset:10496
    ds_read_b64_tr_b16 v[34:35], v11 offset:13056
    s_add_u32 s62, s60, 430080
    s_add_u32 m0, s58, 5120
    s_nop 0
    buffer_load_dwordx4 v1, s[32:35], s62 offen lds
    s_add_u32 m0, s58, 6144
    s_nop 0
    buffer_load_dwordx4 v2, s[32:35], s62 offen lds
    s_add_u32 m0, s58, 7168
    s_nop 0
    buffer_load_dwordx4 v3, s[32:35], s62 offen lds
    s_add_u32 m0, s58, 8192
    s_nop 0
    buffer_load_dwordx4 v4, s[32:35], s62 offen lds
    s_add_u32 m0, s58, 9216
    s_nop 0
    buffer_load_dwordx4 v5, s[32:35], s62 offen lds
    s_add_u32 s63, s61, 21504
    buffer_load_dwordx4 v[44:47], v12, s[28:31], s63 offen sc1
    s_waitcnt lgkmcnt(8)
    v_mfma_f32_32x32x16_bf16 v[80:95], v[16:19], v[48:51], v[80:95]
    s_waitcnt lgkmcnt(6)
    v_mfma_f32_32x32x16_bf16 v[96:111], v[20:23], v[48:51], v[96:111]
    s_waitcnt lgkmcnt(4)
    v_mfma_f32_32x32x16_bf16 v[112:127], v[24:27], v[48:51], v[112:127]
    s_waitcnt lgkmcnt(2)
    v_mfma_f32_32x32x16_bf16 v[128:143], v[28:31], v[48:51], v[128:143]
    s_waitcnt lgkmcnt(0)
    v_mfma_f32_32x32x16_bf16 v[144:159], v[32:35], v[48:51], v[144:159]
    s_waitcnt vmcnt(18)
    ds_read_b64_tr_b16 v[16:17], v11 offset:15360
    ds_read_b64_tr_b16 v[18:19], v11 offset:17920
    ds_read_b64_tr_b16 v[20:21], v11 offset:15424
    ds_read_b64_tr_b16 v[22:23], v11 offset:17984
    ds_read_b64_tr_b16 v[24:25], v11 offset:15488
    ds_read_b64_tr_b16 v[26:27], v11 offset:18048
    ds_read_b64_tr_b16 v[28:29], v11 offset:15552
    ds_read_b64_tr_b16 v[30:31], v11 offset:18112
    ds_read_b64_tr_b16 v[32:33], v11 offset:15616
    ds_read_b64_tr_b16 v[34:35], v11 offset:18176
    s_add_u32 s62, s60, 450560
    s_add_u32 m0, s58, 10240
    s_nop 0
    buffer_load_dwordx4 v1, s[32:35], s62 offen lds
    s_add_u32 m0, s58, 11264
    s_nop 0
    buffer_load_dwordx4 v2, s[32:35], s62 offen lds
    s_add_u32 m0, s58, 12288
    s_nop 0
    buffer_load_dwordx4 v3, s[32:35], s62 offen lds
    s_add_u32 m0, s58, 13312
    s_nop 0
    buffer_load_dwordx4 v4, s[32:35], s62 offen lds
    s_add_u32 m0, s58, 14336
    s_nop 0
    buffer_load_dwordx4 v5, s[32:35], s62 offen lds
    s_add_u32 s63, s61, 22528
    buffer_load_dwordx4 v[48:51], v12, s[28:31], s63 offen sc1
    s_waitcnt lgkmcnt(8)
    v_mfma_f32_32x32x16_bf16 v[80:95], v[16:19], v[52:55], v[80:95]
    s_waitcnt lgkmcnt(6)
    v_mfma_f32_32x32x16_bf16 v[96:111], v[20:23], v[52:55], v[96:111]
    s_waitcnt lgkmcnt(4)
    v_mfma_f32_32x32x16_bf16 v[112:127], v[24:27], v[52:55], v[112:127]
    s_waitcnt lgkmcnt(2)
    v_mfma_f32_32x32x16_bf16 v[128:143], v[28:31], v[52:55], v[128:143]
    s_waitcnt lgkmcnt(0)
    v_mfma_f32_32x32x16_bf16 v[144:159], v[32:35], v[52:55], v[144:159]
    s_waitcnt vmcnt(18)
    ds_read_b64_tr_b16 v[16:17], v11 offset:20480
    ds_read_b64_tr_b16 v[18:19], v11 offset:23040
    ds_read_b64_tr_b16 v[20:21], v11 offset:20544
    ds_read_b64_tr_b16 v[22:23], v11 offset:23104
    ds_read_b64_tr_b16 v[24:25], v11 offset:20608
    ds_read_b64_tr_b16 v[26:27], v11 offset:23168
    ds_read_b64_tr_b16 v[28:29], v11 offset:20672
    ds_read_b64_tr_b16 v[30:31], v11 offset:23232
    ds_read_b64_tr_b16 v[32:33], v11 offset:20736
    ds_read_b64_tr_b16 v[34:35], v11 offset:23296
    s_add_u32 s62, s60, 471040
    s_add_u32 m0, s58, 15360
    s_nop 0
    buffer_load_dwordx4 v1, s[32:35], s62 offen lds
    s_add_u32 m0, s58, 16384
    s_nop 0
    buffer_load_dwordx4 v2, s[32:35], s62 offen lds
    s_add_u32 m0, s58, 17408
    s_nop 0
    buffer_load_dwordx4 v3, s[32:35], s62 offen lds
    s_add_u32 m0, s58, 18432
    s_nop 0
    buffer_load_dwordx4 v4, s[32:35], s62 offen lds
    s_add_u32 m0, s58, 19456
    s_nop 0
    buffer_load_dwordx4 v5, s[32:35], s62 offen lds
    s_add_u32 s63, s61, 23552
    buffer_load_dwordx4 v[52:55], v12, s[28:31], s63 offen sc1
    s_waitcnt lgkmcnt(8)
    v_mfma_f32_32x32x16_bf16 v[80:95], v[16:19], v[56:59], v[80:95]
    s_waitcnt lgkmcnt(6)
    v_mfma_f32_32x32x16_bf16 v[96:111], v[20:23], v[56:59], v[96:111]
    s_waitcnt lgkmcnt(4)
    v_mfma_f32_32x32x16_bf16 v[112:127], v[24:27], v[56:59], v[112:127]
    s_waitcnt lgkmcnt(2)
    v_mfma_f32_32x32x16_bf16 v[128:143], v[28:31], v[56:59], v[128:143]
    s_waitcnt lgkmcnt(0)
    v_mfma_f32_32x32x16_bf16 v[144:159], v[32:35], v[56:59], v[144:159]
    s_waitcnt vmcnt(18)
    ds_read_b64_tr_b16 v[16:17], v11 offset:0
    ds_read_b64_tr_b16 v[18:19], v11 offset:2560
    ds_read_b64_tr_b16 v[20:21], v11 offset:64
    ds_read_b64_tr_b16 v[22:23], v11 offset:2624
    ds_read_b64_tr_b16 v[24:25], v11 offset:128
    ds_read_b64_tr_b16 v[26:27], v11 offset:2688
    ds_read_b64_tr_b16 v[28:29], v11 offset:192
    ds_read_b64_tr_b16 v[30:31], v11 offset:2752
    ds_read_b64_tr_b16 v[32:33], v11 offset:256
    ds_read_b64_tr_b16 v[34:35], v11 offset:2816
    s_waitcnt lgkmcnt(8)
    v_mfma_f32_32x32x16_bf16 v[80:95], v[16:19], v[40:43], v[80:95]
    s_waitcnt lgkmcnt(6)
    v_mfma_f32_32x32x16_bf16 v[96:111], v[20:23], v[40:43], v[96:111]
    s_waitcnt lgkmcnt(4)
    v_mfma_f32_32x32x16_bf16 v[112:127], v[24:27], v[40:43], v[112:127]
    s_waitcnt lgkmcnt(2)
    v_mfma_f32_32x32x16_bf16 v[128:143], v[28:31], v[40:43], v[128:143]
    s_waitcnt lgkmcnt(0)
    v_mfma_f32_32x32x16_bf16 v[144:159], v[32:35], v[40:43], v[144:159]
    s_waitcnt vmcnt(12)
    ds_read_b64_tr_b16 v[16:17], v11 offset:5120
    ds_read_b64_tr_b16 v[18:19], v11 offset:7680
    ds_read_b64_tr_b16 v[20:21], v11 offset:5184
    ds_read_b64_tr_b16 v[22:23], v11 offset:7744
    ds_read_b64_tr_b16 v[24:25], v11 offset:5248
    ds_read_b64_tr_b16 v[26:27], v11 offset:7808
    ds_read_b64_tr_b16 v[28:29], v11 offset:5312
    ds_read_b64_tr_b16 v[30:31], v11 offset:7872
    ds_read_b64_tr_b16 v[32:33], v11 offset:5376
    ds_read_b64_tr_b16 v[34:35], v11 offset:7936
    s_waitcnt lgkmcnt(8)
    v_mfma_f32_32x32x16_bf16 v[80:95], v[16:19], v[44:47], v[80:95]
    s_waitcnt lgkmcnt(6)
    v_mfma_f32_32x32x16_bf16 v[96:111], v[20:23], v[44:47], v[96:111]
    s_waitcnt lgkmcnt(4)
    v_mfma_f32_32x32x16_bf16 v[112:127], v[24:27], v[44:47], v[112:127]
    s_waitcnt lgkmcnt(2)
    v_mfma_f32_32x32x16_bf16 v[128:143], v[28:31], v[44:47], v[128:143]
    s_waitcnt lgkmcnt(0)
    v_mfma_f32_32x32x16_bf16 v[144:159], v[32:35], v[44:47], v[144:159]
    s_waitcnt vmcnt(6)
    ds_read_b64_tr_b16 v[16:17], v11 offset:10240
    ds_read_b64_tr_b16 v[18:19], v11 offset:12800
    ds_read_b64_tr_b16 v[20:21], v11 offset:10304
    ds_read_b64_tr_b16 v[22:23], v11 offset:12864
    ds_read_b64_tr_b16 v[24:25], v11 offset:10368
    ds_read_b64_tr_b16 v[26:27], v11 offset:12928
    ds_read_b64_tr_b16 v[28:29], v11 offset:10432
    ds_read_b64_tr_b16 v[30:31], v11 offset:12992
    ds_read_b64_tr_b16 v[32:33], v11 offset:10496
    ds_read_b64_tr_b16 v[34:35], v11 offset:13056
    s_waitcnt lgkmcnt(8)
    v_mfma_f32_32x32x16_bf16 v[80:95], v[16:19], v[48:51], v[80:95]
    s_waitcnt lgkmcnt(6)
    v_mfma_f32_32x32x16_bf16 v[96:111], v[20:23], v[48:51], v[96:111]
    s_waitcnt lgkmcnt(4)
    v_mfma_f32_32x32x16_bf16 v[112:127], v[24:27], v[48:51], v[112:127]
    s_waitcnt lgkmcnt(2)
    v_mfma_f32_32x32x16_bf16 v[128:143], v[28:31], v[48:51], v[128:143]
    s_waitcnt lgkmcnt(0)
    v_mfma_f32_32x32x16_bf16 v[144:159], v[32:35], v[48:51], v[144:159]
    s_waitcnt vmcnt(0)
    ds_read_b64_tr_b16 v[16:17], v11 offset:15360
    ds_read_b64_tr_b16 v[18:19], v11 offset:17920
    ds_read_b64_tr_b16 v[20:21], v11 offset:15424
    ds_read_b64_tr_b16 v[22:23], v11 offset:17984
    ds_read_b64_tr_b16 v[24:25], v11 offset:15488
    ds_read_b64_tr_b16 v[26:27], v11 offset:18048
    ds_read_b64_tr_b16 v[28:29], v11 offset:15552
    ds_read_b64_tr_b16 v[30:31], v11 offset:18112
    ds_read_b64_tr_b16 v[32:33], v11 offset:15616
    ds_read_b64_tr_b16 v[34:35], v11 offset:18176
    s_waitcnt lgkmcnt(8)
    v_mfma_f32_32x32x16_bf16 v[80:95], v[16:19], v[52:55], v[80:95]
    s_waitcnt lgkmcnt(6)
    v_mfma_f32_32x32x16_bf16 v[96:111], v[20:23], v[52:55], v[96:111]
    s_waitcnt lgkmcnt(4)
    v_mfma_f32_32x32x16_bf16 v[112:127], v[24:27], v[52:55], v[112:127]
    s_waitcnt lgkmcnt(2)
    v_mfma_f32_32x32x16_bf16 v[128:143], v[28:31], v[52:55], v[128:143]
    s_waitcnt lgkmcnt(0)
    v_mfma_f32_32x32x16_bf16 v[144:159], v[32:35], v[52:55], v[144:159]
    s_mul_i32 s60, s22, 320
    s_mul_i32 s3, s20, 204800
    s_add_u32 s60, s60, s3
    s_add_u32 s62, s60, 0
    s_add_u32 m0, s58, 0
    s_nop 0
    buffer_load_dwordx4 v1, s[36:39], s62 offen lds
    s_add_u32 m0, s58, 1024
    s_nop 0
    buffer_load_dwordx4 v2, s[36:39], s62 offen lds
    s_add_u32 m0, s58, 2048
    s_nop 0
    buffer_load_dwordx4 v3, s[36:39], s62 offen lds
    s_add_u32 m0, s58, 3072
    s_nop 0
    buffer_load_dwordx4 v4, s[36:39], s62 offen lds
    s_add_u32 m0, s58, 4096
    s_nop 0
    buffer_load_dwordx4 v5, s[36:39], s62 offen lds
    s_add_u32 s62, s60, 25600
    s_add_u32 m0, s58, 5120
    s_nop 0
    buffer_load_dwordx4 v1, s[36:39], s62 offen lds
    s_add_u32 m0, s58, 6144
    s_nop 0
    buffer_load_dwordx4 v2, s[36:39], s62 offen lds
    s_add_u32 m0, s58, 7168
    s_nop 0
    buffer_load_dwordx4 v3, s[36:39], s62 offen lds
    s_add_u32 m0, s58, 8192
    s_nop 0
    buffer_load_dwordx4 v4, s[36:39], s62 offen lds
    s_add_u32 m0, s58, 9216
    s_nop 0
    buffer_load_dwordx4 v5, s[36:39], s62 offen lds
    s_add_u32 s62, s60, 51200
    s_add_u32 m0, s58, 10240
    s_nop 0
    buffer_load_dwordx4 v1, s[36:39], s62 offen lds
    s_add_u32 m0, s58, 11264
    s_nop 0
    buffer_load_dwordx4 v2, s[36:39], s62 offen lds
    s_add_u32 m0, s58, 12288
    s_nop 0
    buffer_load_dwordx4 v3, s[36:39], s62 offen lds
    s_add_u32 m0, s58, 13312
    s_nop 0
    buffer_load_dwordx4 v4, s[36:39], s62 offen lds
    s_add_u32 m0, s58, 14336
    s_nop 0
    buffer_load_dwordx4 v5, s[36:39], s62 offen lds
    s_add_u32 s62, s60, 76800
    s_add_u32 m0, s58, 15360
    s_nop 0
    buffer_load_dwordx4 v1, s[36:39], s62 offen lds
    s_add_u32 m0, s58, 16384
    s_nop 0
    buffer_load_dwordx4 v2, s[36:39], s62 offen lds
    s_add_u32 m0, s58, 17408
    s_nop 0
    buffer_load_dwordx4 v3, s[36:39], s62 offen lds
    s_add_u32 m0, s58, 18432
    s_nop 0
    buffer_load_dwordx4 v4, s[36:39], s62 offen lds
    s_add_u32 m0, s58, 19456
    s_nop 0
    buffer_load_dwordx4 v5, s[36:39], s62 offen lds
    s_add_u32 s62, s60, 102400
    s_add_u32 m0, s58, 20480
    s_nop 0
    buffer_load_dwordx4 v1, s[36:39], s62 offen lds
    s_add_u32 m0, s58, 21504
    s_nop 0
    buffer_load_dwordx4 v2, s[36:39], s62 offen lds
    s_add_u32 m0, s58, 22528
    s_nop 0
    buffer_load_dwordx4 v3, s[36:39], s62 offen lds
    s_add_u32 m0, s58, 23552
    s_nop 0
    buffer_load_dwordx4 v4, s[36:39], s62 offen lds
    s_add_u32 m0, s58, 24576
    s_nop 0
    buffer_load_dwordx4 v5, s[36:39], s62 offen lds
    s_add_u32 s62, s60, 128000
    buffer_load_dwordx4 v[40:43], v1, s[36:39], s62 offen
    buffer_load_dwordx4 v[40:43], v2, s[36:39], s62 offen
    buffer_load_dwordx4 v[40:43], v3, s[36:39], s62 offen
    buffer_load_dwordx4 v[40:43], v4, s[36:39], s62 offen
    buffer_load_dwordx4 v[40:43], v5, s[36:39], s62 offen
    s_add_u32 s62, s60, 153600
    buffer_load_dwordx4 v[40:43], v1, s[36:39], s62 offen
    buffer_load_dwordx4 v[40:43], v2, s[36:39], s62 offen
    buffer_load_dwordx4 v[40:43], v3, s[36:39], s62 offen
    buffer_load_dwordx4 v[40:43], v4, s[36:39], s62 offen
    buffer_load_dwordx4 v[40:43], v5, s[36:39], s62 offen
    s_add_u32 s62, s60, 179200
    buffer_load_dwordx4 v[40:43], v1, s[36:39], s62 offen
    buffer_load_dwordx4 v[40:43], v2, s[36:39], s62 offen
    buffer_load_dwordx4 v[40:43], v3, s[36:39], s62 offen
    buffer_load_dwordx4 v[40:43], v4, s[36:39], s62 offen
    buffer_load_dwordx4 v[40:43], v5, s[36:39], s62 offen
    s_add_u32 s62, s60, 20480
    buffer_load_dwordx4 v[40:43], v6, s[36:39], s62 offen
    buffer_load_dwordx4 v[40:43], v7, s[36:39], s62 offen
    buffer_load_dwordx4 v[40:43], v8, s[36:39], s62 offen
    buffer_load_dwordx4 v[40:43], v9, s[36:39], s62 offen
    buffer_load_dwordx4 v[40:43], v10, s[36:39], s62 offen
    s_add_u32 s62, s60, 122880
    buffer_load_dwordx4 v[40:43], v6, s[36:39], s62 offen
    buffer_load_dwordx4 v[40:43], v7, s[36:39], s62 offen
    buffer_load_dwordx4 v[40:43], v8, s[36:39], s62 offen
    buffer_load_dwordx4 v[40:43], v9, s[36:39], s62 offen
    buffer_load_dwordx4 v[40:43], v10, s[36:39], s62 offen
    v_sub_f32 v160, 1.0, v160
    s_nop 7
    v_mul_f32 v80, v80, v160
    v_mul_f32 v81, v81, v160
    v_mul_f32 v82, v82, v160
    v_mul_f32 v83, v83, v160
    v_mul_f32 v84, v84, v160
    v_mul_f32 v85, v85, v160
    v_mul_f32 v86, v86, v160
    v_mul_f32 v87, v87, v160
    v_mul_f32 v88, v88, v160
    v_mul_f32 v89, v89, v160
    v_mul_f32 v90, v90, v160
    v_mul_f32 v91, v91, v160
    v_mul_f32 v92, v92, v160
    v_mul_f32 v93, v93, v160
    v_mul_f32 v94, v94, v160
    v_mul_f32 v95, v95, v160
    v_mul_f32 v96, v96, v160
    v_mul_f32 v97, v97, v160
    v_mul_f32 v98, v98, v160
    v_mul_f32 v99, v99, v160
    v_mul_f32 v100, v100, v160
    v_mul_f32 v101, v101, v160
    v_mul_f32 v102, v102, v160
    v_mul_f32 v103, v103, v160
    v_mul_f32 v104, v104, v160
    v_mul_f32 v105, v105, v160
    v_mul_f32 v106, v106, v160
    v_mul_f32 v107, v107, v160
    v_mul_f32 v108, v108, v160
    v_mul_f32 v109, v109, v160
    v_mul_f32 v110, v110, v160
    v_mul_f32 v111, v111, v160
    v_mul_f32 v112, v112, v160
    v_mul_f32 v113, v113, v160
    v_mul_f32 v114, v114, v160
    v_mul_f32 v115, v115, v160
    v_mul_f32 v116, v116, v160
    v_mul_f32 v117, v117, v160
    v_mul_f32 v118, v118, v160
    v_mul_f32 v119, v119, v160
    v_mul_f32 v120, v120, v160
    v_mul_f32 v121, v121, v160
    v_mul_f32 v122, v122, v160
    v_mul_f32 v123, v123, v160
    v_mul_f32 v124, v124, v160
    v_mul_f32 v125, v125, v160
    v_mul_f32 v126, v126, v160
    v_mul_f32 v127, v127, v160
    v_mul_f32 v128, v128, v160
    v_mul_f32 v129, v129, v160
    v_mul_f32 v130, v130, v160
    v_mul_f32 v131, v131, v160
    v_mul_f32 v132, v132, v160
    v_mul_f32 v133, v133, v160
    v_mul_f32 v134, v134, v160
    v_mul_f32 v135, v135, v160
    v_mul_f32 v136, v136, v160
    v_mul_f32 v137, v137, v160
    v_mul_f32 v138, v138, v160
    v_mul_f32 v139, v139, v160
    v_mul_f32 v140, v140, v160
    v_mul_f32 v141, v141, v160
    v_mul_f32 v142, v142, v160
    v_mul_f32 v143, v143, v160
    v_mul_f32 v144, v144, v160
    v_mul_f32 v145, v145, v160
    v_mul_f32 v146, v146, v160
    v_mul_f32 v147, v147, v160
    v_mul_f32 v148, v148, v160
    v_mul_f32 v149, v149, v160
    v_mul_f32 v150, v150, v160
    v_mul_f32 v151, v151, v160
    v_mul_f32 v152, v152, v160
    v_mul_f32 v153, v153, v160
    v_mul_f32 v154, v154, v160
    v_mul_f32 v155, v155, v160
    v_mul_f32 v156, v156, v160
    v_mul_f32 v157, v157, v160
    v_mul_f32 v158, v158, v160
    v_mul_f32 v159, v159, v160
    s_waitcnt vmcnt(0)
    ds_read_b64_tr_b16 v[16:17], v11 offset:0
    ds_read_b64_tr_b16 v[18:19], v11 offset:2560
    ds_read_b64_tr_b16 v[20:21], v11 offset:64
    ds_read_b64_tr_b16 v[22:23], v11 offset:2624
    ds_read_b64_tr_b16 v[24:25], v11 offset:128
    ds_read_b64_tr_b16 v[26:27], v11 offset:2688
    ds_read_b64_tr_b16 v[28:29], v11 offset:192
    ds_read_b64_tr_b16 v[30:31], v11 offset:2752
    ds_read_b64_tr_b16 v[32:33], v11 offset:256
    ds_read_b64_tr_b16 v[34:35], v11 offset:2816
    v_mov_b32 v13, 159744
    s_cmp_lg_u32 s20, s22
    s_cbranch_scc1 K2_GW2
K2_GW:
    s_sleep 2
    ds_read_b32 v14, v13 offset:4
    s_waitcnt lgkmcnt(0)
    v_readfirstlane_b32 s3, v14
    s_cmp_ge_u32 s3, 8
    s_cbranch_scc0 K2_GW
K2_GW2:
    v_mov_b32 v13, 0
K2_POLL0:
    s_lshl_b32 s62, s21, 2
    s_add_u32 s62, s62, s20
    s_lshl_b32 s62, s62, 7
    s_add_u32 s62, s62, 2949120
    s_mov_b32 s63, 0
    s_cmp_eq_u32 s20, s22
    s_cbranch_scc1 K2_GO
K2_POLL:
    buffer_load_dword v14, v13, s[28:31], s62 offen sc1
    s_waitcnt vmcnt(0)
    v_readfirstlane_b32 s3, v14
    s_cmp_eq_u32 s3, s77
    s_cbranch_scc1 K2_GO
    s_sleep 3
    s_add_u32 s63, s63, 1
    s_cmp_lt_u32 s63, 0x100000
    s_cbranch_scc1 K2_POLL
K2_GO:
    s_mul_i32 s61, s21, 40
    s_lshl_b32 s61, s61, 10
    s_add_u32 s61, s61, 9437184
    s_lshl_b32 s3, s20, 11
    s_add_u32 s63, s61, s3
    s_add_u32 s63, s63, 32768
    s_lshl_b32 s3, s20, 13
    s_add_u32 s61, s61, s3
    s_add_u32 s56, s61, 4096
    v_and_b32 v36, 31, v0
    v_lshlrev_b32 v36, 3, v36
    v_lshrrev_b32 v37, 5, v0
    v_lshl_add_u32 v36, v37, 9, v36
    buffer_load_dwordx4 v[40:43], v12, s[28:31], s61 offen offset:0 sc1
    buffer_load_dwordx4 v[44:47], v12, s[28:31], s61 offen offset:1024 sc1
    buffer_load_dwordx4 v[48:51], v12, s[28:31], s61 offen offset:2048 sc1
    buffer_load_dwordx4 v[52:55], v12, s[28:31], s61 offen offset:3072 sc1
    buffer_load_dwordx4 v[56:59], v12, s[28:31], s56 offen offset:0 sc1
    ds_read_b64_tr_b16 v[60:61], v11 offset:5120
    ds_read_b64_tr_b16 v[62:63], v11 offset:7680
    ds_read_b64_tr_b16 v[64:65], v11 offset:5184
    ds_read_b64_tr_b16 v[66:67], v11 offset:7744
    ds_read_b64_tr_b16 v[68:69], v11 offset:5248
    ds_read_b64_tr_b16 v[70:71], v11 offset:7808
    ds_read_b64_tr_b16 v[72:73], v11 offset:5312
    ds_read_b64_tr_b16 v[74:75], v11 offset:7872
    ds_read_b64_tr_b16 v[76:77], v11 offset:5376
    ds_read_b64_tr_b16 v[78:79], v11 offset:7936
    s_waitcnt vmcnt(0)
    s_waitcnt lgkmcnt(10)
    v_mfma_f32_32x32x16_bf16 v[80:95], v[16:19], v[40:43], v[80:95]
    v_mfma_f32_32x32x16_bf16 v[96:111], v[20:23], v[40:43], v[96:111]
    v_mfma_f32_32x32x16_bf16 v[112:127], v[24:27], v[40:43], v[112:127]
    v_mfma_f32_32x32x16_bf16 v[128:143], v[28:31], v[40:43], v[128:143]
    v_mfma_f32_32x32x16_bf16 v[144:159], v[32:35], v[40:43], v[144:159]
    s_add_u32 s62, s60, 128000
    s_add_u32 m0, s58, 0
    s_nop 0
    buffer_load_dwordx4 v1, s[36:39], s62 offen lds
    s_add_u32 m0, s58, 1024
    s_nop 0
    buffer_load_dwordx4 v2, s[36:39], s62 offen lds
    s_add_u32 m0, s58, 2048
    s_nop 0
    buffer_load_dwordx4 v3, s[36:39], s62 offen lds
    s_add_u32 m0, s58, 3072
    s_nop 0
    buffer_load_dwordx4 v4, s[36:39], s62 offen lds
    s_add_u32 m0, s58, 4096
    s_nop 0
    buffer_load_dwordx4 v5, s[36:39], s62 offen lds
    buffer_load_dwordx4 v[40:43], v12, s[28:31], s56 offen offset:1024 sc1
    ds_read_b64_tr_b16 v[16:17], v11 offset:10240
    ds_read_b64_tr_b16 v[18:19], v11 offset:12800
    ds_read_b64_tr_b16 v[20:21], v11 offset:10304
    ds_read_b64_tr_b16 v[22:23], v11 offset:12864
    ds_read_b64_tr_b16 v[24:25], v11 offset:10368
    ds_read_b64_tr_b16 v[26:27], v11 offset:12928
    ds_read_b64_tr_b16 v[28:29], v11 offset:10432
    ds_read_b64_tr_b16 v[30:31], v11 offset:12992
    ds_read_b64_tr_b16 v[32:33], v11 offset:10496
    ds_read_b64_tr_b16 v[34:35], v11 offset:13056
    s_waitcnt lgkmcnt(10)
    v_mfma_f32_32x32x16_bf16 v[80:95], v[60:63], v[44:47], v[80:95]
    v_mfma_f32_32x32x16_bf16 v[96:111], v[64:67], v[44:47], v[96:111]
    v_mfma_f32_32x32x16_bf16 v[112:127], v[68:71], v[44:47], v[112:127]
    v_mfma_f32_32x32x16_bf16 v[128:143], v[72:75], v[44:47], v[128:143]
    v_mfma_f32_32x32x16_bf16 v[144:159], v[76:79], v[44:47], v[144:159]
    s_add_u32 s62, s60, 153600
    s_add_u32 m0, s58, 5120
    s_nop 0
    buffer_load_dwordx4 v1, s[36:39], s62 offen lds
    s_add_u32 m0, s58, 6144
    s_nop 0
    buffer_load_dwordx4 v2, s[36:39], s62 offen lds
    s_add_u32 m0, s58, 7168
    s_nop 0
    buffer_load_dwordx4 v3, s[36:39], s62 offen lds
    s_add_u32 m0, s58, 8192
    s_nop 0
    buffer_load_dwordx4 v4, s[36:39], s62 offen lds
    s_add_u32 m0, s58, 9216
    s_nop 0
    buffer_load_dwordx4 v5, s[36:39], s62 offen lds
    buffer_load_dwordx4 v[44:47], v12, s[28:31], s56 offen offset:2048 sc1
    ds_read_b64_tr_b16 v[60:61], v11 offset:15360
    ds_read_b64_tr_b16 v[62:63], v11 offset:17920
    ds_read_b64_tr_b16 v[64:65], v11 offset:15424
    ds_read_b64_tr_b16 v[66:67], v11 offset:17984
    ds_read_b64_tr_b16 v[68:69], v11 offset:15488
    ds_read_b64_tr_b16 v[70:71], v11 offset:18048
    ds_read_b64_tr_b16 v[72:73], v11 offset:15552
    ds_read_b64_tr_b16 v[74:75], v11 offset:18112
    ds_read_b64_tr_b16 v[76:77], v11 offset:15616
    ds_read_b64_tr_b16 v[78:79], v11 offset:18176
    s_waitcnt lgkmcnt(10)
    v_mfma_f32_32x32x16_bf16 v[80:95], v[16:19], v[48:51], v[80:95]
    v_mfma_f32_32x32x16_bf16 v[96:111], v[20:23], v[48:51], v[96:111]
    v_mfma_f32_32x32x16_bf16 v[112:127], v[24:27], v[48:51], v[112:127]
    v_mfma_f32_32x32x16_bf16 v[128:143], v[28:31], v[48:51], v[128:143]
    v_mfma_f32_32x32x16_bf16 v[144:159], v[32:35], v[48:51], v[144:159]
    s_add_u32 s62, s60, 179200
    s_add_u32 m0, s58, 10240
    s_nop 0
    buffer_load_dwordx4 v1, s[36:39], s62 offen lds
    s_add_u32 m0, s58, 11264
    s_nop 0
    buffer_load_dwordx4 v2, s[36:39], s62 offen lds
    s_add_u32 m0, s58, 12288
    s_nop 0
    buffer_load_dwordx4 v3, s[36:39], s62 offen lds
    s_add_u32 m0, s58, 13312
    s_nop 0
    buffer_load_dwordx4 v4, s[36:39], s62 offen lds
    s_add_u32 m0, s58, 14336
    s_nop 0
    buffer_load_dwordx4 v5, s[36:39], s62 offen lds
    buffer_load_dwordx4 v[48:51], v12, s[28:31], s56 offen offset:3072 sc1
    ds_read_b64_tr_b16 v[16:17], v11 offset:20480
    ds_read_b64_tr_b16 v[18:19], v11 offset:23040
    ds_read_b64_tr_b16 v[20:21], v11 offset:20544
    ds_read_b64_tr_b16 v[22:23], v11 offset:23104
    ds_read_b64_tr_b16 v[24:25], v11 offset:20608
    ds_read_b64_tr_b16 v[26:27], v11 offset:23168
    ds_read_b64_tr_b16 v[28:29], v11 offset:20672
    ds_read_b64_tr_b16 v[30:31], v11 offset:23232
    ds_read_b64_tr_b16 v[32:33], v11 offset:20736
    ds_read_b64_tr_b16 v[34:35], v11 offset:23296
    s_waitcnt lgkmcnt(10)
    v_mfma_f32_32x32x16_bf16 v[80:95], v[60:63], v[52:55], v[80:95]
    v_mfma_f32_32x32x16_bf16 v[96:111], v[64:67], v[52:55], v[96:111]
    v_mfma_f32_32x32x16_bf16 v[112:127], v[68:71], v[52:55], v[112:127]
    v_mfma_f32_32x32x16_bf16 v[128:143], v[72:75], v[52:55], v[128:143]
    v_mfma_f32_32x32x16_bf16 v[144:159], v[76:79], v[52:55], v[144:159]
    s_add_u32 s62, s60, 20480
    s_add_u32 m0, s58, 15360
    s_nop 0
    buffer_load_dwordx4 v6, s[36:39], s62 offen lds
    s_add_u32 m0, s58, 16384
    s_nop 0
    buffer_load_dwordx4 v7, s[36:39], s62 offen lds
    s_add_u32 m0, s58, 17408
    s_nop 0
    buffer_load_dwordx4 v8, s[36:39], s62 offen lds
    s_add_u32 m0, s58, 18432
    s_nop 0
    buffer_load_dwordx4 v9, s[36:39], s62 offen lds
    s_add_u32 m0, s58, 19456
    s_nop 0
    buffer_load_dwordx4 v10, s[36:39], s62 offen lds
    buffer_load_dwordx2 v[52:53], v36, s[28:31], s63 offen offset:0 sc1
    buffer_load_dwordx2 v[54:55], v36, s[28:31], s63 offen offset:256 sc1
    s_waitcnt vmcnt(20)
    ds_read_b64_tr_b16 v[60:61], v11 offset:0
    ds_read_b64_tr_b16 v[62:63], v11 offset:2560
    ds_read_b64_tr_b16 v[64:65], v11 offset:64
    ds_read_b64_tr_b16 v[66:67], v11 offset:2624
    ds_read_b64_tr_b16 v[68:69], v11 offset:128
    ds_read_b64_tr_b16 v[70:71], v11 offset:2688
    ds_read_b64_tr_b16 v[72:73], v11 offset:192
    ds_read_b64_tr_b16 v[74:75], v11 offset:2752
    ds_read_b64_tr_b16 v[76:77], v11 offset:256
    ds_read_b64_tr_b16 v[78:79], v11 offset:2816
    s_waitcnt lgkmcnt(10)
    v_mfma_f32_32x32x16_bf16 v[80:95], v[16:19], v[56:59], v[80:95]
    v_mfma_f32_32x32x16_bf16 v[96:111], v[20:23], v[56:59], v[96:111]
    v_mfma_f32_32x32x16_bf16 v[112:127], v[24:27], v[56:59], v[112:127]
    v_mfma_f32_32x32x16_bf16 v[128:143], v[28:31], v[56:59], v[128:143]
    v_mfma_f32_32x32x16_bf16 v[144:159], v[32:35], v[56:59], v[144:159]
    s_add_u32 s62, s60, 122880
    s_add_u32 m0, s58, 20480
    s_nop 0
    buffer_load_dwordx4 v6, s[36:39], s62 offen lds
    s_add_u32 m0, s58, 21504
    s_nop 0
    buffer_load_dwordx4 v7, s[36:39], s62 offen lds
    s_add_u32 m0, s58, 22528
    s_nop 0
    buffer_load_dwordx4 v8, s[36:39], s62 offen lds
    s_add_u32 m0, s58, 23552
    s_nop 0
    buffer_load_dwordx4 v9, s[36:39], s62 offen lds
    s_add_u32 m0, s58, 24576
    s_nop 0
    buffer_load_dwordx4 v10, s[36:39], s62 offen lds
    buffer_load_dwordx2 v[56:57], v36, s[28:31], s63 offen offset:1024 sc1
    buffer_load_dwordx2 v[58:59], v36, s[28:31], s63 offen offset:1280 sc1
    s_waitcnt vmcnt(21)
    ds_read_b64_tr_b16 v[16:17], v11 offset:5120
    ds_read_b64_tr_b16 v[18:19], v11 offset:7680
    ds_read_b64_tr_b16 v[20:21], v11 offset:5184
    ds_read_b64_tr_b16 v[22:23], v11 offset:7744
    ds_read_b64_tr_b16 v[24:25], v11 offset:5248
    ds_read_b64_tr_b16 v[26:27], v11 offset:7808
    ds_read_b64_tr_b16 v[28:29], v11 offset:5312
    ds_read_b64_tr_b16 v[30:31], v11 offset:7872
    ds_read_b64_tr_b16 v[32:33], v11 offset:5376
    ds_read_b64_tr_b16 v[34:35], v11 offset:7936
    s_waitcnt vmcnt(26)
    s_waitcnt lgkmcnt(10)
    v_mfma_f32_32x32x16_bf16 v[80:95], v[60:63], v[40:43], v[80:95]
    v_mfma_f32_32x32x16_bf16 v[96:111], v[64:67], v[40:43], v[96:111]
    v_mfma_f32_32x32x16_bf16 v[112:127], v[68:71], v[40:43], v[112:127]
    v_mfma_f32_32x32x16_bf16 v[128:143], v[72:75], v[40:43], v[128:143]
    v_mfma_f32_32x32x16_bf16 v[144:159], v[76:79], v[40:43], v[144:159]
    s_waitcnt vmcnt(15)
    ds_read_b64_tr_b16 v[60:61], v11 offset:10240
    ds_read_b64_tr_b16 v[62:63], v11 offset:12800
    ds_read_b64_tr_b16 v[64:65], v11 offset:10304
    ds_read_b64_tr_b16 v[66:67], v11 offset:12864
    ds_read_b64_tr_b16 v[68:69], v11 offset:10368
    ds_read_b64_tr_b16 v[70:71], v11 offset:12928
    ds_read_b64_tr_b16 v[72:73], v11 offset:10432
    ds_read_b64_tr_b16 v[74:75], v11 offset:12992
    ds_read_b64_tr_b16 v[76:77], v11 offset:10496
    ds_read_b64_tr_b16 v[78:79], v11 offset:13056
    s_waitcnt vmcnt(20)
    s_waitcnt lgkmcnt(10)
    v_mfma_f32_32x32x16_bf16 v[80:95], v[16:19], v[44:47], v[80:95]
    v_mfma_f32_32x32x16_bf16 v[96:111], v[20:23], v[44:47], v[96:111]
    v_mfma_f32_32x32x16_bf16 v[112:127], v[24:27], v[44:47], v[112:127]
    v_mfma_f32_32x32x16_bf16 v[128:143], v[28:31], v[44:47], v[128:143]
    v_mfma_f32_32x32x16_bf16 v[144:159], v[32:35], v[44:47], v[144:159]
    s_waitcnt vmcnt(9)
    ds_read_b64_tr_b16 v[16:17], v11 offset:15360
    ds_read_b64_tr_b16 v[18:19], v11 offset:17920
    ds_read_b64_tr_b16 v[20:21], v11 offset:15424
    ds_read_b64_tr_b16 v[22:23], v11 offset:17984
    ds_read_b64_tr_b16 v[24:25], v11 offset:15488
    ds_read_b64_tr_b16 v[26:27], v11 offset:18048
    ds_read_b64_tr_b16 v[28:29], v11 offset:15552
    ds_read_b64_tr_b16 v[30:31], v11 offset:18112
    ds_read_b64_tr_b16 v[32:33], v11 offset:15616
    ds_read_b64_tr_b16 v[34:35], v11 offset:18176
    s_waitcnt vmcnt(14)
    s_waitcnt lgkmcnt(10)
    v_mfma_f32_32x32x16_bf16 v[80:95], v[60:63], v[48:51], v[80:95]
    v_mfma_f32_32x32x16_bf16 v[96:111], v[64:67], v[48:51], v[96:111]
    v_mfma_f32_32x32x16_bf16 v[112:127], v[68:71], v[48:51], v[112:127]
    v_mfma_f32_32x32x16_bf16 v[128:143], v[72:75], v[48:51], v[128:143]
    v_mfma_f32_32x32x16_bf16 v[144:159], v[76:79], v[48:51], v[144:159]
    s_waitcnt vmcnt(2)
    ds_read_b64_tr_b16 v[60:61], v11 offset:20480
    ds_read_b64_tr_b16 v[62:63], v11 offset:23040
    ds_read_b64_tr_b16 v[64:65], v11 offset:20544
    ds_read_b64_tr_b16 v[66:67], v11 offset:23104
    ds_read_b64_tr_b16 v[68:69], v11 offset:20608
    ds_read_b64_tr_b16 v[70:71], v11 offset:23168
    ds_read_b64_tr_b16 v[72:73], v11 offset:20672
    ds_read_b64_tr_b16 v[74:75], v11 offset:23232
    ds_read_b64_tr_b16 v[76:77], v11 offset:20736
    ds_read_b64_tr_b16 v[78:79], v11 offset:23296
    s_waitcnt vmcnt(7)
    s_waitcnt lgkmcnt(10)
    v_mfma_f32_32x32x16_bf16 v[80:95], v[16:19], v[52:55], v[80:95]
    v_mfma_f32_32x32x16_bf16 v[96:111], v[20:23], v[52:55], v[96:111]
    v_mfma_f32_32x32x16_bf16 v[112:127], v[24:27], v[52:55], v[112:127]
    v_mfma_f32_32x32x16_bf16 v[128:143], v[28:31], v[52:55], v[128:143]
    v_mfma_f32_32x32x16_bf16 v[144:159], v[32:35], v[52:55], v[144:159]
    s_waitcnt vmcnt(0)
    s_waitcnt lgkmcnt(0)
    v_mfma_f32_32x32x16_bf16 v[80:95], v[60:63], v[56:59], v[80:95]
    v_mfma_f32_32x32x16_bf16 v[96:111], v[64:67], v[56:59], v[96:111]
    v_mfma_f32_32x32x16_bf16 v[112:127], v[68:71], v[56:59], v[112:127]
    v_mfma_f32_32x32x16_bf16 v[128:143], v[72:75], v[56:59], v[128:143]
    v_mfma_f32_32x32x16_bf16 v[144:159], v[76:79], v[56:59], v[144:159]
    s_nop 15
    v_add_u32 v13, s58, v12
    ds_write_b128 v13, v[80:83] offset:0
    ds_write_b128 v13, v[84:87] offset:1024
    ds_write_b128 v13, v[88:91] offset:2048
    ds_write_b128 v13, v[92:95] offset:3072
    ds_write_b128 v13, v[96:99] offset:4096
    ds_write_b128 v13, v[100:103] offset:5120
    ds_write_b128 v13, v[104:107] offset:6144
    ds_write_b128 v13, v[108:111] offset:7168
    ds_write_b128 v13, v[112:115] offset:8192
    ds_write_b128 v13, v[116:119] offset:9216
    ds_write_b128 v13, v[120:123] offset:10240
    ds_write_b128 v13, v[124:127] offset:11264
    ds_write_b128 v13, v[128:131] offset:12288
    ds_write_b128 v13, v[132:135] offset:13312
    ds_write_b128 v13, v[136:139] offset:14336
    ds_write_b128 v13, v[140:143] offset:15360
    ds_write_b128 v13, v[144:147] offset:16384
    ds_write_b128 v13, v[148:151] offset:17408
    ds_write_b128 v13, v[152:155] offset:18432
    ds_write_b128 v13, v[156:159] offset:19456
    s_waitcnt lgkmcnt(0)
    s_barrier
    s_mul_i32 s57, s20, 5120
    s_add_u32 s57, s57, 57344
    v_add_u32 v13, s57, v12
    v_add_u32 v14, 51200, v13
    ds_read_b128 v[80:83], v13 offset:0
    ds_read_b128 v[84:87], v13 offset:1024
    ds_read_b128 v[88:91], v13 offset:2048
    ds_read_b128 v[92:95], v13 offset:3072
    ds_read_b128 v[96:99], v13 offset:4096
    ds_read_b128 v[100:103], v13 offset:25600
    ds_read_b128 v[104:107], v13 offset:26624
    ds_read_b128 v[108:111], v13 offset:27648
    ds_read_b128 v[112:115], v13 offset:28672
    ds_read_b128 v[116:119], v13 offset:29696
    ds_read_b128 v[120:123], v14 offset:0
    ds_read_b128 v[124:127], v14 offset:1024
    ds_read_b128 v[128:131], v14 offset:2048
    ds_read_b128 v[132:135], v14 offset:3072
    ds_read_b128 v[136:139], v14 offset:4096
    ds_read_b128 v[140:143], v14 offset:25600
    ds_read_b128 v[144:147], v14 offset:26624
    ds_read_b128 v[148:151], v14 offset:27648
    ds_read_b128 v[152:155], v14 offset:28672
    ds_read_b128 v[156:159], v14 offset:29696
    s_waitcnt lgkmcnt(0)
    v_add_f32 v80, v80, v100
    v_add_f32 v81, v81, v101
    v_add_f32 v82, v82, v102
    v_add_f32 v83, v83, v103
    v_add_f32 v84, v84, v104
    v_add_f32 v85, v85, v105
    v_add_f32 v86, v86, v106
    v_add_f32 v87, v87, v107
    v_add_f32 v88, v88, v108
    v_add_f32 v89, v89, v109
    v_add_f32 v90, v90, v110
    v_add_f32 v91, v91, v111
    v_add_f32 v92, v92, v112
    v_add_f32 v93, v93, v113
    v_add_f32 v94, v94, v114
    v_add_f32 v95, v95, v115
    v_add_f32 v96, v96, v116
    v_add_f32 v97, v97, v117
    v_add_f32 v98, v98, v118
    v_add_f32 v99, v99, v119
    v_add_f32 v80, v80, v120
    v_add_f32 v81, v81, v121
    v_add_f32 v82, v82, v122
    v_add_f32 v83, v83, v123
    v_add_f32 v84, v84, v124
    v_add_f32 v85, v85, v125
    v_add_f32 v86, v86, v126
    v_add_f32 v87, v87, v127
    v_add_f32 v88, v88, v128
    v_add_f32 v89, v89, v129
    v_add_f32 v90, v90, v130
    v_add_f32 v91, v91, v131
    v_add_f32 v92, v92, v132
    v_add_f32 v93, v93, v133
    v_add_f32 v94, v94, v134
    v_add_f32 v95, v95, v135
    v_add_f32 v96, v96, v136
    v_add_f32 v97, v97, v137
    v_add_f32 v98, v98, v138
    v_add_f32 v99, v99, v139
    v_add_f32 v80, v80, v140
    v_add_f32 v81, v81, v141
    v_add_f32 v82, v82, v142
    v_add_f32 v83, v83, v143
    v_add_f32 v84, v84, v144
    v_add_f32 v85, v85, v145
    v_add_f32 v86, v86, v146
    v_add_f32 v87, v87, v147
    v_add_f32 v88, v88, v148
    v_add_f32 v89, v89, v149
    v_add_f32 v90, v90, v150
    v_add_f32 v91, v91, v151
    v_add_f32 v92, v92, v152
    v_add_f32 v93, v93, v153
    v_add_f32 v94, v94, v154
    v_add_f32 v95, v95, v155
    v_add_f32 v96, v96, v156
    v_add_f32 v97, v97, v157
    v_add_f32 v98, v98, v158
    v_add_f32 v99, v99, v159
    v_cvt_pk_bf16_f32 v100, v80, v81
    v_cvt_pk_bf16_f32 v101, v82, v83
    v_cvt_pk_bf16_f32 v102, v84, v85
    v_cvt_pk_bf16_f32 v103, v86, v87
    v_cvt_pk_bf16_f32 v104, v88, v89
    v_cvt_pk_bf16_f32 v105, v90, v91
    v_cvt_pk_bf16_f32 v106, v92, v93
    v_cvt_pk_bf16_f32 v107, v94, v95
    v_cvt_pk_bf16_f32 v108, v96, v97
    v_cvt_pk_bf16_f32 v109, v98, v99
    v_and_b32 v13, 31, v0
    v_mul_u32_u24 v13, 0x500, v13
    v_lshrrev_b32 v14, 5, v0
    v_lshl_add_u32 v13, v14, 3, v13
    s_mul_i32 s3, s21, 40960
    s_mul_i32 s62, s22, 320
    s_add_u32 s3, s3, s62
    s_mul_i32 s62, s20, 80
    s_add_u32 s3, s3, s62
    buffer_store_dwordx2 v[100:101], v13, s[40:43], s3 offen offset:0
    buffer_store_dwordx2 v[102:103], v13, s[40:43], s3 offen offset:16
    buffer_store_dwordx2 v[104:105], v13, s[40:43], s3 offen offset:32
    buffer_store_dwordx2 v[106:107], v13, s[40:43], s3 offen offset:48
    buffer_store_dwordx2 v[108:109], v13, s[40:43], s3 offen offset:64
K2_END:
    s_endpgm
.section .rodata,"a"

.p2align 6
.amdhsa_kernel gated_mix__grouped_kv_mqa__glu_gated_reglu__prompt_kernel
  .amdhsa_next_free_vgpr 168
  .amdhsa_next_free_sgpr 100
  .amdhsa_accum_offset 168
  .amdhsa_group_segment_fixed_size 0
  .amdhsa_kernarg_size 104
  .amdhsa_user_sgpr_count 2
  .amdhsa_user_sgpr_kernarg_segment_ptr 1
  .amdhsa_system_sgpr_workgroup_id_x 1
.end_amdhsa_kernel
```
